```python
import torch

def _softmax(x, axis=-1):
    return torch.softmax(x, dim=axis)
def _gelu(x):
    return torch.nn.functional.gelu(x, approximate="tanh")
def _silu(x):
    return torch.nn.functional.silu(x)
def _sigmoid(x):
    return torch.sigmoid(x)
def _layernorm(x, axis=-1, eps=1e-5):
    m = x.mean(dim=axis, keepdim=True)
    v = x.var(dim=axis, keepdim=True, unbiased=False)
    return (x - m) / torch.sqrt(v + eps)
def _scatter_add(tgt, idx, src, axis=0):
    return tgt.clone().index_add_(axis, idx, src)
def _segment_sum(src, seg, n):
    out = torch.zeros((n,) + src.shape[1:], dtype=src.dtype)
    return out.index_add_(0, seg, src)
def _pad(x, pw):
    flat = tuple(v for pair in reversed(pw) for v in pair)
    return torch.nn.functional.pad(x, flat)

kernel_name = 'standalone__weight_only_int_quip__prompt'

def setup_inputs():

    _w = (lambda a: (lambda t: t.to(torch.bfloat16) if t.is_floating_point() else t)(torch.as_tensor(a)))
    B, S, D, F = 1, 2048, 640, 1728
    G = 128 if 128 > 0 else D
    D = (D // G) * G
    ng = D // G
    bits = 4 if 4 > 0 else 4
    qmax = 1 << bits
    qw = torch.randint(0, qmax, (D, F)).to(torch.int32)
    U, _ = (lambda *_a, **_k: torch.linalg.qr(*[torch.as_tensor(_x).float() for _x in _a], **_k))((lambda *s: torch.randn(*s, dtype=torch.bfloat16) * 0.05)(D, D))
    V, _ = (lambda *_a, **_k: torch.linalg.qr(*[torch.as_tensor(_x).float() for _x in _a], **_k))((lambda *s: torch.randn(*s, dtype=torch.bfloat16) * 0.05)(F, F))
    return {
        "x": _w((lambda *s: torch.randn(*s, dtype=torch.bfloat16) * 0.05)(B, S, D)),
        "qw": _w(qw),
        "scales": _w(torch.abs((lambda *s: torch.randn(*s, dtype=torch.bfloat16) * 0.05)(ng, F)) * 0.02 + 0.005),
        "zeros": _w(torch.full((ng, F), qmax / 2.0, dtype=float)),
        "U": _w(U.to(float)),
        "V": _w(V.to(float)),
    }

def reference(x, qw, scales, zeros, U, V):
    B, S, D = x.shape
    ng, F = scales.shape
    G = D // ng
    s = (lambda x, n, axis: torch.repeat_interleave(x, n, dim=axis))(scales, G, axis=0)
    z = (lambda x, n, axis: torch.repeat_interleave(x, n, dim=axis))(zeros, G, axis=0)
    wq = ((lambda x, dt: x.to(dt))(qw, x.dtype) - z) * s
    xr = torch.einsum("bsd,de->bse", x, U)
    h  = torch.einsum("bse,ef->bsf", xr, wq)
    y  = torch.einsum("bsf,fg->bsg", h, V)
    return y
```

```asm
; @launch grid=(256,1,1) block=(256,1,1) lds=163840
.amdgcn_target "amdgcn-amd-amdhsa--gfx950"
.text
.globl standalone__weight_only_int_quip__prompt_kernel
.p2align 8
.type standalone__weight_only_int_quip__prompt_kernel,@function
standalone__weight_only_int_quip__prompt_kernel:
    s_cmp_ge_u32 s2, 256
    s_cbranch_scc1 Lfin_2
    s_load_dwordx2 s[88:89], s[0:1], 56
    s_load_dwordx2 s[20:21], s[0:1], 64
    s_load_dwordx2 s[16:17], s[0:1], 48
    s_memrealtime s[96:97]
    v_lshrrev_b32 v1, 6, v0
    v_and_b32 v0, 63, v0
    s_and_b32 s22, s2, 7
    v_readfirstlane_b32 s3, v1
    s_lshr_b32 s23, s2, 3
    v_lshlrev_b32 v4, 4, v0
    s_mov_b32 s90, 256
    s_mov_b32 s91, 0x20000
    s_cmp_lg_u32 s2, 0
    s_cbranch_scc1 Ltok
    s_cmp_lg_u32 s3, 0
    s_cbranch_scc1 Ltok
    s_waitcnt lgkmcnt(0)
    s_or_b32 s96, s96, 1
    v_mov_b32 v14, s96
    v_mov_b32 v15, 0
    buffer_store_dword v14, v15, s[88:91], 0 offen sc0 sc1
Ltok:
    s_getpc_b64 s[52:53]
Lpc:
    s_lshl_b32 s54, s23, 10
    v_and_b32 v2, 7, v0
    v_lshl_add_u32 v2, v2, 7, s54
    v_min_u32 v2, Lcode_end - Lpc - 4, v2
    global_load_dword v252, v2, s[52:53]
    s_mov_b32 s53, 0
    s_mov_b32 s54, 0
    s_mov_b32 s55, 0
    s_cmp_eq_u32 s22, 0
    s_cselect_b32 s55, 0, s55
    s_cmp_eq_u32 s22, 1
    s_cselect_b32 s55, 160, s55
    s_cselect_b32 s53, 22, s53
    s_cselect_b32 s54, 0, s54
    s_cmp_eq_u32 s22, 2
    s_cselect_b32 s55, 32, s55
    s_cmp_eq_u32 s22, 3
    s_cselect_b32 s55, 170, s55
    s_cselect_b32 s53, 22, s53
    s_cselect_b32 s54, 22, s54
    s_cmp_eq_u32 s22, 4
    s_cselect_b32 s55, 64, s55
    s_cmp_eq_u32 s22, 5
    s_cselect_b32 s55, 180, s55
    s_cselect_b32 s53, 21, s53
    s_cselect_b32 s54, 44, s54
    s_cmp_eq_u32 s22, 6
    s_cselect_b32 s55, 96, s55
    s_cmp_eq_u32 s22, 7
    s_cselect_b32 s55, 128, s55
    s_cmp_ge_u32 s23, s53
    s_cbranch_scc1 Lt_5_c
    s_add_u32 s52, s54, s23
    s_cmp_lt_u32 s52, 65
    s_cbranch_scc1 Lxr_3
    s_branch Lfin_2
Lt_5_c:
    s_sub_u32 s52, s23, s53
    s_add_u32 s52, s52, s55
    s_cmp_ge_u32 s52, 189
    s_cbranch_scc1 Lfin_2
Lt_5:
    s_load_dwordx2 s[24:25], s[0:1], 8
    s_load_dwordx2 s[28:29], s[0:1], 16
    s_load_dwordx2 s[32:33], s[0:1], 24
    s_load_dwordx2 s[36:37], s[0:1], 40
    s_mov_b32 s85, s52
    s_sub_u32 s53, s52, 108
    s_and_b32 s53, s53, 0xfff
    s_mul_i32 s54, s53, 21846
    s_lshr_b32 s54, s54, 16
    s_mul_i32 s55, s54, 3
    s_sub_u32 s55, s53, s55
    s_add_u32 s55, s55, 4
    s_lshr_b32 s49, s52, 2
    s_and_b32 s48, s52, 3
    s_cmp_ge_u32 s52, 108
    s_cselect_b32 s49, s54, s49
    s_cselect_b32 s48, s55, s48
    s_lshl_b32 s57, s49, 7
    s_mul_i32 s58, s3, 40960
    s_mov_b32 s38, 5971968
    s_mov_b32 s39, 0x20000
    s_cmp_eq_u32 s3, 3
    s_cbranch_scc1 Lloader_6
    v_lshrrev_b32 v2, 2, v0
    v_mul_u32_u24 v2, 6912, v2
    v_and_b32 v3, 3, v0
    v_lshl_add_u32 v2, v3, 4, v2
    v_and_b32 v5, 31, v0
    v_lshlrev_b32 v5, 2, v5
    s_lshl_b32 s55, s3, 5
    s_mul_i32 s77, s48, 96
    s_add_u32 s77, s77, s55
    s_mul_i32 s79, s77, 6912
    s_lshl_b32 s53, s57, 1
    s_add_u32 s79, s79, s53
    s_add_u32 s80, s79, 110592
    s_lshr_b32 s78, s77, 7
    s_mul_i32 s82, s78, 3456
    s_add_u32 s82, s82, s57
    s_add_u32 m0, s58, 36864
    s_mov_b32 s26, 4423680
    s_mov_b32 s27, 0x20000
    s_mov_b32 s30, 17280
    s_mov_b32 s31, 0x20000
    s_mov_b32 s34, 17280
    s_mov_b32 s35, 0x20000
    s_waitcnt lgkmcnt(0)
    buffer_load_dword v5, s[28:31], s82 offen lds
    s_add_u32 m0, s58, 37120
    buffer_load_dwordx4 v[16:19], v2, s[24:27], s79 offen offset:0
    buffer_load_dword v5, s[32:35], s82 offen lds
    buffer_load_dwordx4 v[20:23], v2, s[24:27], s79 offen offset:128
    buffer_load_dwordx4 v[24:27], v2, s[24:27], s79 offen offset:64
    buffer_load_dwordx4 v[28:31], v2, s[24:27], s79 offen offset:192
    buffer_load_dwordx4 v[32:35], v2, s[24:27], s80 offen offset:0
    buffer_load_dwordx4 v[36:39], v2, s[24:27], s80 offen offset:128
    buffer_load_dwordx4 v[40:43], v2, s[24:27], s80 offen offset:64
    buffer_load_dwordx4 v[44:47], v2, s[24:27], s80 offen offset:192
    s_add_u32 s44, s20, 12582912
    s_addc_u32 s45, s21, 0
    s_mov_b32 s46, 1048576
    s_mov_b32 s47, 0x20000
    s_add_u32 s40, s20, 0
    s_addc_u32 s41, s21, 0
    s_mov_b32 s42, 2211840
    s_mov_b32 s43, 0x20000
    s_mul_i32 s79, s49, 81920
    s_lshr_b32 s53, s77, 4
    s_lshl_b32 s53, s53, 11
    s_add_u32 s79, s79, s53
    s_cmp_ge_u32 s77, 640
    s_cselect_b32 s79, 1073741824, s79
    s_add_u32 s53, s58, 32768
    v_lshlrev_b32 v1, 8, v3
    v_lshrrev_b32 v6, 2, v0
    v_lshl_add_u32 v1, v6, 4, v1
    v_add_u32 v96, s53, v1
    v_add_u32 v97, s53, v4
    s_add_u32 s53, s53, 4096
    v_lshl_add_u32 v98, v3, 3, s53
    s_add_u32 s50, s48, s49
    s_and_b32 s50, s50, 1
    s_mul_i32 s50, s50, 3
    s_cmp_ge_u32 s48, 4
    s_cselect_b32 s52, 1, 0
    s_add_u32 s50, s50, s52
    s_mul_i32 s56, s3, 7
    s_mul_i32 s59, s48, 12288
    v_lshrrev_b32 v5, 3, v0
    v_mul_u32_u24 v5, 3456, v5
    v_bfe_u32 v1, v0, 4, 1
    v_and_b32 v6, 7, v0
    v_xor_b32 v1, v1, v6
    v_lshl_add_u32 v240, v1, 4, v5
    v_add_u32 v241, 26624, v240
    v_add_u32 v242, 53248, v240
    v_add_u32 v243, 79872, v240
    s_add_u32 s52, s50, 0
    s_cmp_ge_u32 s52, 7
    s_cselect_b32 s53, 7, 0
    s_sub_u32 s52, s52, s53
    s_add_u32 s52, s52, s56
    s_mul_i32 s60, s52, 221184
    s_add_u32 s60, s60, s57
    s_mul_i32 s68, s52, 81920
    s_add_u32 s68, s68, s59
    s_add_u32 s52, s50, 1
    s_cmp_ge_u32 s52, 7
    s_cselect_b32 s53, 7, 0
    s_sub_u32 s52, s52, s53
    s_add_u32 s52, s52, s56
    s_mul_i32 s61, s52, 221184
    s_add_u32 s61, s61, s57
    s_mul_i32 s69, s52, 81920
    s_add_u32 s69, s69, s59
    s_add_u32 s52, s50, 2
    s_cmp_ge_u32 s52, 7
    s_cselect_b32 s53, 7, 0
    s_sub_u32 s52, s52, s53
    s_add_u32 s52, s52, s56
    s_mul_i32 s62, s52, 221184
    s_add_u32 s62, s62, s57
    s_mul_i32 s70, s52, 81920
    s_add_u32 s70, s70, s59
    s_add_u32 s52, s50, 3
    s_cmp_ge_u32 s52, 7
    s_cselect_b32 s53, 7, 0
    s_sub_u32 s52, s52, s53
    s_add_u32 s52, s52, s56
    s_mul_i32 s63, s52, 221184
    s_add_u32 s63, s63, s57
    s_mul_i32 s71, s52, 81920
    s_add_u32 s71, s71, s59
    s_add_u32 s52, s50, 4
    s_cmp_ge_u32 s52, 7
    s_cselect_b32 s53, 7, 0
    s_sub_u32 s52, s52, s53
    s_add_u32 s52, s52, s56
    s_mul_i32 s64, s52, 221184
    s_add_u32 s64, s64, s57
    s_mul_i32 s72, s52, 81920
    s_add_u32 s72, s72, s59
    s_add_u32 s52, s50, 5
    s_cmp_ge_u32 s52, 7
    s_cselect_b32 s53, 7, 0
    s_sub_u32 s52, s52, s53
    s_add_u32 s52, s52, s56
    s_mul_i32 s65, s52, 221184
    s_add_u32 s65, s65, s57
    s_mul_i32 s73, s52, 81920
    s_add_u32 s73, s73, s59
    s_add_u32 s52, s50, 6
    s_cmp_ge_u32 s52, 7
    s_cselect_b32 s53, 7, 0
    s_sub_u32 s52, s52, s53
    s_add_u32 s52, s52, s56
    s_mul_i32 s66, s52, 221184
    s_add_u32 s66, s66, s57
    s_mul_i32 s74, s52, 81920
    s_add_u32 s74, s74, s59
    s_waitcnt vmcnt(7)
    ds_read2_b64 v[48:51], v98 offset0:0 offset1:8
    ds_read2_b64 v[56:59], v98 offset0:32 offset1:40
    ds_read2_b64 v[52:55], v98 offset0:4 offset1:12
    ds_read2_b64 v[60:63], v98 offset0:36 offset1:44
    s_waitcnt lgkmcnt(0)
    v_lshlrev_b32 v64, 16, v56
    v_and_b32 v65, 0xffff0000, v56
    v_lshlrev_b32 v72, 16, v48
    v_and_b32 v73, 0xffff0000, v48
    v_lshlrev_b32 v66, 16, v57
    v_and_b32 v67, 0xffff0000, v57
    v_lshlrev_b32 v74, 16, v49
    v_and_b32 v75, 0xffff0000, v49
    v_lshlrev_b32 v68, 16, v58
    v_and_b32 v69, 0xffff0000, v58
    v_lshlrev_b32 v76, 16, v50
    v_and_b32 v77, 0xffff0000, v50
    v_lshlrev_b32 v70, 16, v59
    v_and_b32 v71, 0xffff0000, v59
    v_lshlrev_b32 v78, 16, v51
    v_and_b32 v79, 0xffff0000, v51
    v_lshlrev_b32 v80, 16, v60
    v_and_b32 v81, 0xffff0000, v60
    v_lshlrev_b32 v88, 16, v52
    v_and_b32 v89, 0xffff0000, v52
    v_lshlrev_b32 v82, 16, v61
    v_and_b32 v83, 0xffff0000, v61
    v_lshlrev_b32 v90, 16, v53
    v_and_b32 v91, 0xffff0000, v53
    v_lshlrev_b32 v84, 16, v62
    v_and_b32 v85, 0xffff0000, v62
    v_lshlrev_b32 v92, 16, v54
    v_and_b32 v93, 0xffff0000, v54
    v_lshlrev_b32 v86, 16, v63
    v_and_b32 v87, 0xffff0000, v63
    v_lshlrev_b32 v94, 16, v55
    v_and_b32 v95, 0xffff0000, v55
    s_waitcnt vmcnt(6)
    v_cvt_f32_i32 v16, v16
    v_cvt_f32_i32 v17, v17
    v_cvt_f32_i32 v18, v18
    v_cvt_f32_i32 v19, v19
    v_cvt_f32_i32 v20, v20
    v_cvt_f32_i32 v21, v21
    v_cvt_f32_i32 v22, v22
    v_cvt_f32_i32 v23, v23
    v_sub_f32 v16, v16, v64
    v_sub_f32 v17, v17, v65
    v_sub_f32 v18, v18, v66
    v_sub_f32 v19, v19, v67
    v_sub_f32 v20, v20, v68
    v_sub_f32 v21, v21, v69
    v_sub_f32 v22, v22, v70
    v_sub_f32 v23, v23, v71
    v_mul_f32 v16, v16, v72
    v_mul_f32 v17, v17, v73
    v_mul_f32 v18, v18, v74
    v_mul_f32 v19, v19, v75
    v_mul_f32 v20, v20, v76
    v_mul_f32 v21, v21, v77
    v_mul_f32 v22, v22, v78
    v_mul_f32 v23, v23, v79
    v_cvt_pk_bf16_f32 v16, v16, v17
    v_cvt_pk_bf16_f32 v17, v18, v19
    v_cvt_pk_bf16_f32 v18, v20, v21
    v_cvt_pk_bf16_f32 v19, v22, v23
    ds_write_b128 v96, v[16:19] offset:0
    ds_read_b128 v[20:23], v97 offset:0
    s_waitcnt vmcnt(4)
    v_cvt_f32_i32 v24, v24
    v_cvt_f32_i32 v25, v25
    v_cvt_f32_i32 v26, v26
    v_cvt_f32_i32 v27, v27
    v_cvt_f32_i32 v28, v28
    v_cvt_f32_i32 v29, v29
    v_cvt_f32_i32 v30, v30
    v_cvt_f32_i32 v31, v31
    v_sub_f32 v24, v24, v80
    v_sub_f32 v25, v25, v81
    v_sub_f32 v26, v26, v82
    v_sub_f32 v27, v27, v83
    v_sub_f32 v28, v28, v84
    v_sub_f32 v29, v29, v85
    v_sub_f32 v30, v30, v86
    v_sub_f32 v31, v31, v87
    v_mul_f32 v24, v24, v88
    v_mul_f32 v25, v25, v89
    v_mul_f32 v26, v26, v90
    v_mul_f32 v27, v27, v91
    v_mul_f32 v28, v28, v92
    v_mul_f32 v29, v29, v93
    v_mul_f32 v30, v30, v94
    v_mul_f32 v31, v31, v95
    v_cvt_pk_bf16_f32 v24, v24, v25
    v_cvt_pk_bf16_f32 v25, v26, v27
    v_cvt_pk_bf16_f32 v26, v28, v29
    v_cvt_pk_bf16_f32 v27, v30, v31
    ds_write_b128 v96, v[24:27] offset:1024
    ds_read_b128 v[28:31], v97 offset:1024
    s_waitcnt lgkmcnt(2)
    buffer_store_dwordx4 v[20:23], v4, s[40:43], s79 offen offset:0 sc0 sc1
    s_waitcnt vmcnt(3)
    v_cvt_f32_i32 v32, v32
    v_cvt_f32_i32 v33, v33
    v_cvt_f32_i32 v34, v34
    v_cvt_f32_i32 v35, v35
    v_cvt_f32_i32 v36, v36
    v_cvt_f32_i32 v37, v37
    v_cvt_f32_i32 v38, v38
    v_cvt_f32_i32 v39, v39
    v_sub_f32 v32, v32, v64
    v_sub_f32 v33, v33, v65
    v_sub_f32 v34, v34, v66
    v_sub_f32 v35, v35, v67
    v_sub_f32 v36, v36, v68
    v_sub_f32 v37, v37, v69
    v_sub_f32 v38, v38, v70
    v_sub_f32 v39, v39, v71
    v_mul_f32 v32, v32, v72
    v_mul_f32 v33, v33, v73
    v_mul_f32 v34, v34, v74
    v_mul_f32 v35, v35, v75
    v_mul_f32 v36, v36, v76
    v_mul_f32 v37, v37, v77
    v_mul_f32 v38, v38, v78
    v_mul_f32 v39, v39, v79
    v_cvt_pk_bf16_f32 v32, v32, v33
    v_cvt_pk_bf16_f32 v33, v34, v35
    v_cvt_pk_bf16_f32 v34, v36, v37
    v_cvt_pk_bf16_f32 v35, v38, v39
    ds_write_b128 v96, v[32:35] offset:2048
    ds_read_b128 v[36:39], v97 offset:2048
    s_waitcnt lgkmcnt(2)
    buffer_store_dwordx4 v[28:31], v4, s[40:43], s79 offen offset:1024 sc0 sc1
    s_waitcnt vmcnt(2)
    v_cvt_f32_i32 v40, v40
    v_cvt_f32_i32 v41, v41
    v_cvt_f32_i32 v42, v42
    v_cvt_f32_i32 v43, v43
    v_cvt_f32_i32 v44, v44
    v_cvt_f32_i32 v45, v45
    v_cvt_f32_i32 v46, v46
    v_cvt_f32_i32 v47, v47
    v_sub_f32 v40, v40, v80
    v_sub_f32 v41, v41, v81
    v_sub_f32 v42, v42, v82
    v_sub_f32 v43, v43, v83
    v_sub_f32 v44, v44, v84
    v_sub_f32 v45, v45, v85
    v_sub_f32 v46, v46, v86
    v_sub_f32 v47, v47, v87
    v_mul_f32 v40, v40, v88
    v_mul_f32 v41, v41, v89
    v_mul_f32 v42, v42, v90
    v_mul_f32 v43, v43, v91
    v_mul_f32 v44, v44, v92
    v_mul_f32 v45, v45, v93
    v_mul_f32 v46, v46, v94
    v_mul_f32 v47, v47, v95
    v_cvt_pk_bf16_f32 v40, v40, v41
    v_cvt_pk_bf16_f32 v41, v42, v43
    v_cvt_pk_bf16_f32 v42, v44, v45
    v_cvt_pk_bf16_f32 v43, v46, v47
    ds_write_b128 v96, v[40:43] offset:3072
    ds_read_b128 v[44:47], v97 offset:3072
    s_waitcnt lgkmcnt(2)
    buffer_store_dwordx4 v[36:39], v4, s[40:43], s79 offen offset:2048 sc0 sc1
    s_waitcnt lgkmcnt(0)
    buffer_store_dwordx4 v[44:47], v4, s[40:43], s79 offen offset:3072 sc0 sc1
    s_load_dword s87, s[88:89], 0
    s_add_u32 s40, s20, 0
    s_addc_u32 s41, s21, 0
    s_mov_b32 s42, 2211840
    s_mov_b32 s43, 0x20000
    s_and_b32 s4, s22, 3
    s_lshl_b32 s4, s4, 2
    s_and_b32 s52, s23, 3
    s_add_u32 s4, s4, s52
    s_lshr_b32 s5, s22, 2
    s_mul_i32 s5, s5, 7
    s_lshr_b32 s52, s23, 2
    s_add_u32 s5, s5, s52
    s_min_u32 s5, s5, 13
    s_lshl_b32 s52, s4, 2
    s_add_u32 s52, s52, s3
    s_mul_i32 s53, s52, 40960
    s_add_u32 s53, s53, 8388608
    s_add_u32 s92, s20, s53
    s_addc_u32 s93, s21, 0
    s_mov_b32 s94, 40960
    s_mov_b32 s95, 0x20000
    s_mul_i32 s52, s52, 13108
    s_lshr_b32 s52, s52, 16
    s_mul_i32 s7, s52, 640
    s_add_u32 s7, s7, 524288
    s_lshl_b32 s52, s5, 2
    s_add_u32 s52, s52, s3
    s_mul_i32 s53, s52, 40960
    s_mov_b32 s14, 40960
    s_add_u32 s53, s53, 4194304
    s_add_u32 s12, s20, s53
    s_addc_u32 s13, s21, 0
    s_mov_b32 s15, 0x20000
    s_mul_i32 s8, s52, 6144
    s_add_u32 s8, s8, 131072
    s_add_u32 s9, s8, 2048
    s_add_u32 s10, s8, 4096
    s_mul_i32 s58, s3, 40960
    s_add_u32 s52, s4, s5
    s_and_b32 s52, s52, 1
    s_mul_i32 s18, s52, 6144
    s_mul_i32 s19, s52, -8192
    s_mul_i32 s6, s52, -6144
    s_cmp_ge_u32 s23, 28
    s_cselect_b32 s14, 0, s14
    s_cselect_b32 s94, 0, s94
    v_add_u32 v6, 4096, v4
    v_add_u32 v7, 8192, v4
    v_mov_b32 v1, 1073741824
    s_cmp_eq_u32 s48, 6
    s_cselect_b64 vcc, -1, 0
    v_lshrrev_b32 v2, 2, v0
    v_cndmask_b32 v7, v7, v1, vcc
    v_lshlrev_b32 v2, 7, v2
    v_add_u32 v2, s58, v2
    v_and_b32 v3, 3, v0
    v_lshlrev_b32 v3, 1, v3
    v_bfe_u32 v1, v0, 3, 1
    v_xor_b32 v3, v3, v1
    s_add_u32 s52, s3, 0
    s_bfe_u32 s53, s52, 0x10001
    s_and_b32 s52, s52, 1
    s_lshl_b32 s52, s52, 3
    v_xor_b32 v1, s53, v3
    v_lshl_add_u32 v1, v1, 4, v2
    v_add_u32 v10, s52, v1
    s_add_u32 s52, s3, 1
    s_bfe_u32 s53, s52, 0x10001
    s_and_b32 s52, s52, 1
    s_lshl_b32 s52, s52, 3
    v_xor_b32 v1, s53, v3
    v_lshl_add_u32 v1, v1, 4, v2
    v_add_u32 v11, s52, v1
    s_add_u32 s52, s3, 2
    s_bfe_u32 s53, s52, 0x10001
    s_and_b32 s52, s52, 1
    s_lshl_b32 s52, s52, 3
    v_xor_b32 v1, s53, v3
    v_lshl_add_u32 v1, v1, 4, v2
    v_add_u32 v12, s52, v1
    s_add_u32 s52, s3, 3
    s_bfe_u32 s53, s52, 0x10001
    s_and_b32 s52, s52, 1
    s_lshl_b32 s52, s52, 3
    v_xor_b32 v1, s53, v3
    v_lshl_add_u32 v1, v1, 4, v2
    v_add_u32 v13, s52, v1
    v_min_u32 v9, 20, v0
    v_mul_u32_u24 v1, 21846, v9
    v_lshrrev_b32 v1, 16, v1
    v_mul_u32_u24 v8, 3, v1
    v_sub_u32 v9, v9, v8
    v_add_u32 v1, s56, v1
    v_min_u32 v1, 26, v1
    v_lshlrev_b32 v9, 7, v9
    v_lshl_add_u32 v9, v1, 9, v9
    s_lshl_b32 s75, s48, 14
    s_lshl_b32 s83, s49, 9
    s_add_u32 s83, s83, s75
    s_lshl_b32 s52, s3, 7
    s_add_u32 s83, s83, s52
    s_add_u32 s24, s20, 4194304
    s_addc_u32 s25, s21, 0
    s_mov_b32 s26, 2293760
    s_mov_b32 s27, 0x20000
    s_add_u32 s52, s58, 28672
    v_add_u32 v244, s52, v4
    s_sub_u32 s52, s3, 1
    s_and_b32 s52, s52, 3
    s_mul_i32 s52, s52, 40960
    s_add_u32 s52, s52, 28672
    v_add_u32 v245, s52, v4
    s_sub_u32 s52, s3, 2
    s_and_b32 s52, s52, 3
    s_mul_i32 s52, s52, 40960
    s_add_u32 s52, s52, 28672
    v_add_u32 v246, s52, v4
    s_sub_u32 s52, s3, 3
    s_and_b32 s52, s52, 3
    s_mul_i32 s52, s52, 40960
    s_add_u32 s52, s52, 28672
    v_add_u32 v247, s52, v4
    s_lshr_b32 s52, s49, 1
    s_lshl_b32 s52, s52, 2
    s_add_u32 s52, s52, s3
    s_mul_i32 s52, s52, 40
    s_lshl_b32 s53, s48, 1
    s_add_u32 s52, s52, s53
    s_and_b32 s53, s49, 1
    s_add_u32 s52, s52, s53
    s_lshl_b32 s76, s52, 10
    s_add_u32 s81, s76, 14336
    s_add_u32 s77, s76, 28672
    s_cmp_eq_u32 s48, 6
    s_cselect_b32 s77, 1073741824, s77
    s_lshr_b32 s52, s49, 1
    s_lshl_b32 s52, s52, 2
    s_add_u32 s52, s52, s3
    s_mul_i32 s52, s52, 48
    s_and_b32 s53, s49, 1
    s_mul_i32 s53, s53, 7
    s_add_u32 s53, s53, s48
    s_add_u32 s53, s53, s52
    s_add_u32 s53, s53, 1024
    s_lshl_b32 s78, s53, 7
    s_add_u32 s79, s78, 2048
    s_add_u32 s80, s78, 4096
    s_waitcnt vmcnt(0)
    s_waitcnt lgkmcnt(0)
    s_cmp_lg_u32 s87, 0
    s_cbranch_scc1 Ltk_9
    s_mov_b32 s86, 0
    v_mov_b32 v15, 0
Ltk_8:
    buffer_load_dword v14, v15, s[88:91], 0 offen sc0 sc1
    s_add_u32 s86, s86, 1
    s_cmp_gt_u32 s86, 524288
    s_cbranch_scc1 Lend_1
    s_waitcnt vmcnt(0)
    v_readfirstlane_b32 s87, v14
    s_nop 3
    s_cmp_lg_u32 s87, 0
    s_cbranch_scc0 Ltk_8
Ltk_9:
    v_mov_b32 v14, s87
    v_lshlrev_b32 v15, 2, v0
    v_and_b32 v1, 32, v0
    v_lshl_add_u32 v15, v1, 24, v15
    buffer_store_dword v14, v15, s[44:47], s83 offen offset:0 sc0 sc1
    s_branch Lb1_7
Lloader_6:
    s_add_u32 s50, s48, s49
    s_and_b32 s50, s50, 1
    s_mul_i32 s50, s50, 3
    s_cmp_ge_u32 s48, 4
    s_cselect_b32 s52, 1, 0
    s_add_u32 s50, s50, s52
    s_mul_i32 s56, s3, 7
    s_mul_i32 s59, s48, 12288
    v_lshrrev_b32 v5, 3, v0
    v_mul_u32_u24 v5, 3456, v5
    v_bfe_u32 v1, v0, 4, 1
    v_and_b32 v6, 7, v0
    v_xor_b32 v1, v1, v6
    v_lshl_add_u32 v240, v1, 4, v5
    v_add_u32 v241, 26624, v240
    v_add_u32 v242, 53248, v240
    v_add_u32 v243, 79872, v240
    s_add_u32 s52, s50, 0
    s_cmp_ge_u32 s52, 7
    s_cselect_b32 s53, 7, 0
    s_sub_u32 s52, s52, s53
    s_add_u32 s52, s52, s56
    s_mul_i32 s60, s52, 221184
    s_add_u32 s60, s60, s57
    s_mul_i32 s68, s52, 81920
    s_add_u32 s68, s68, s59
    s_waitcnt lgkmcnt(0)
    s_add_u32 s44, s20, 12582912
    s_addc_u32 s45, s21, 0
    s_mov_b32 s46, 1048576
    s_mov_b32 s47, 0x20000
    s_add_u32 s52, s50, 1
    s_cmp_ge_u32 s52, 7
    s_cselect_b32 s53, 7, 0
    s_sub_u32 s52, s52, s53
    s_add_u32 s52, s52, s56
    s_mul_i32 s61, s52, 221184
    s_add_u32 s61, s61, s57
    s_mul_i32 s69, s52, 81920
    s_add_u32 s69, s69, s59
    s_add_u32 s52, s50, 2
    s_cmp_ge_u32 s52, 7
    s_cselect_b32 s53, 7, 0
    s_sub_u32 s52, s52, s53
    s_add_u32 s52, s52, s56
    s_mul_i32 s62, s52, 221184
    s_add_u32 s62, s62, s57
    s_mul_i32 s70, s52, 81920
    s_add_u32 s70, s70, s59
    s_add_u32 s52, s50, 3
    s_cmp_ge_u32 s52, 7
    s_cselect_b32 s53, 7, 0
    s_sub_u32 s52, s52, s53
    s_add_u32 s52, s52, s56
    s_mul_i32 s63, s52, 221184
    s_add_u32 s63, s63, s57
    s_mul_i32 s71, s52, 81920
    s_add_u32 s71, s71, s59
    s_add_u32 s52, s50, 4
    s_cmp_ge_u32 s52, 7
    s_cselect_b32 s53, 7, 0
    s_sub_u32 s52, s52, s53
    s_add_u32 s52, s52, s56
    s_mul_i32 s64, s52, 221184
    s_add_u32 s64, s64, s57
    s_mul_i32 s72, s52, 81920
    s_add_u32 s72, s72, s59
    s_add_u32 s52, s50, 5
    s_cmp_ge_u32 s52, 7
    s_cselect_b32 s53, 7, 0
    s_sub_u32 s52, s52, s53
    s_add_u32 s52, s52, s56
    s_mul_i32 s65, s52, 221184
    s_add_u32 s65, s65, s57
    s_mul_i32 s73, s52, 81920
    s_add_u32 s73, s73, s59
    s_add_u32 s52, s50, 6
    s_cmp_ge_u32 s52, 7
    s_cselect_b32 s53, 7, 0
    s_sub_u32 s52, s52, s53
    s_add_u32 s52, s52, s56
    s_mul_i32 s66, s52, 221184
    s_add_u32 s66, s66, s57
    s_mul_i32 s74, s52, 81920
    s_add_u32 s74, s74, s59
    s_add_u32 s40, s20, 0
    s_addc_u32 s41, s21, 0
    s_mov_b32 s42, 2211840
    s_mov_b32 s43, 0x20000
    s_and_b32 s4, s22, 3
    s_lshl_b32 s4, s4, 2
    s_and_b32 s52, s23, 3
    s_add_u32 s4, s4, s52
    s_lshr_b32 s5, s22, 2
    s_mul_i32 s5, s5, 7
    s_lshr_b32 s52, s23, 2
    s_add_u32 s5, s5, s52
    s_min_u32 s5, s5, 13
    s_lshl_b32 s52, s4, 2
    s_add_u32 s52, s52, s3
    s_mul_i32 s53, s52, 40960
    s_add_u32 s53, s53, 8388608
    s_add_u32 s92, s20, s53
    s_addc_u32 s93, s21, 0
    s_mov_b32 s94, 40960
    s_mov_b32 s95, 0x20000
    s_mul_i32 s52, s52, 13108
    s_lshr_b32 s52, s52, 16
    s_mul_i32 s7, s52, 640
    s_add_u32 s7, s7, 524288
    s_lshl_b32 s52, s5, 2
    s_add_u32 s52, s52, s3
    s_mul_i32 s53, s52, 40960
    s_mov_b32 s14, 40960
    s_add_u32 s53, s53, 4194304
    s_add_u32 s12, s20, s53
    s_addc_u32 s13, s21, 0
    s_mov_b32 s15, 0x20000
    s_mul_i32 s8, s52, 6144
    s_add_u32 s8, s8, 131072
    s_add_u32 s9, s8, 2048
    s_add_u32 s10, s8, 4096
    s_mul_i32 s58, s3, 40960
    s_add_u32 s52, s4, s5
    s_and_b32 s52, s52, 1
    s_mul_i32 s18, s52, 6144
    s_mul_i32 s19, s52, -8192
    s_mul_i32 s6, s52, -6144
    s_cmp_ge_u32 s23, 28
    s_cselect_b32 s14, 0, s14
    s_cselect_b32 s94, 0, s94
    v_add_u32 v6, 4096, v4
    v_add_u32 v7, 8192, v4
    v_mov_b32 v1, 1073741824
    s_cmp_eq_u32 s48, 6
    s_cselect_b64 vcc, -1, 0
    v_lshrrev_b32 v2, 2, v0
    v_cndmask_b32 v7, v7, v1, vcc
    v_lshlrev_b32 v2, 7, v2
    v_add_u32 v2, s58, v2
    v_and_b32 v3, 3, v0
    v_lshlrev_b32 v3, 1, v3
    v_bfe_u32 v1, v0, 3, 1
    v_xor_b32 v3, v3, v1
    s_add_u32 s52, s3, 0
    s_bfe_u32 s53, s52, 0x10001
    s_and_b32 s52, s52, 1
    s_lshl_b32 s52, s52, 3
    v_xor_b32 v1, s53, v3
    v_lshl_add_u32 v1, v1, 4, v2
    v_add_u32 v10, s52, v1
    s_add_u32 s52, s3, 1
    s_bfe_u32 s53, s52, 0x10001
    s_and_b32 s52, s52, 1
    s_lshl_b32 s52, s52, 3
    v_xor_b32 v1, s53, v3
    v_lshl_add_u32 v1, v1, 4, v2
    v_add_u32 v11, s52, v1
    s_add_u32 s52, s3, 2
    s_bfe_u32 s53, s52, 0x10001
    s_and_b32 s52, s52, 1
    s_lshl_b32 s52, s52, 3
    v_xor_b32 v1, s53, v3
    v_lshl_add_u32 v1, v1, 4, v2
    v_add_u32 v12, s52, v1
    s_add_u32 s52, s3, 3
    s_bfe_u32 s53, s52, 0x10001
    s_and_b32 s52, s52, 1
    s_lshl_b32 s52, s52, 3
    v_xor_b32 v1, s53, v3
    v_lshl_add_u32 v1, v1, 4, v2
    v_add_u32 v13, s52, v1
    v_min_u32 v9, 20, v0
    v_mul_u32_u24 v1, 21846, v9
    v_lshrrev_b32 v1, 16, v1
    v_mul_u32_u24 v8, 3, v1
    v_sub_u32 v9, v9, v8
    v_add_u32 v1, s56, v1
    v_min_u32 v1, 26, v1
    v_lshlrev_b32 v9, 7, v9
    v_lshl_add_u32 v9, v1, 9, v9
    s_lshl_b32 s75, s48, 14
    s_lshl_b32 s83, s49, 9
    s_add_u32 s83, s83, s75
    s_lshl_b32 s52, s3, 7
    s_add_u32 s83, s83, s52
    s_add_u32 s24, s20, 4194304
    s_addc_u32 s25, s21, 0
    s_mov_b32 s26, 2293760
    s_mov_b32 s27, 0x20000
    s_add_u32 s52, s58, 28672
    v_add_u32 v244, s52, v4
    s_sub_u32 s52, s3, 1
    s_and_b32 s52, s52, 3
    s_mul_i32 s52, s52, 40960
    s_add_u32 s52, s52, 28672
    v_add_u32 v245, s52, v4
    s_sub_u32 s52, s3, 2
    s_and_b32 s52, s52, 3
    s_mul_i32 s52, s52, 40960
    s_add_u32 s52, s52, 28672
    v_add_u32 v246, s52, v4
    s_sub_u32 s52, s3, 3
    s_and_b32 s52, s52, 3
    s_mul_i32 s52, s52, 40960
    s_add_u32 s52, s52, 28672
    v_add_u32 v247, s52, v4
    s_lshr_b32 s52, s49, 1
    s_lshl_b32 s52, s52, 2
    s_add_u32 s52, s52, s3
    s_mul_i32 s52, s52, 40
    s_lshl_b32 s53, s48, 1
    s_add_u32 s52, s52, s53
    s_and_b32 s53, s49, 1
    s_add_u32 s52, s52, s53
    s_lshl_b32 s76, s52, 10
    s_add_u32 s81, s76, 14336
    s_add_u32 s77, s76, 28672
    s_cmp_eq_u32 s48, 6
    s_cselect_b32 s77, 1073741824, s77
    s_lshr_b32 s52, s49, 1
    s_lshl_b32 s52, s52, 2
    s_add_u32 s52, s52, s3
    s_mul_i32 s52, s52, 48
    s_and_b32 s53, s49, 1
    s_mul_i32 s53, s53, 7
    s_add_u32 s53, s53, s48
    s_add_u32 s53, s53, s52
    s_add_u32 s53, s53, 1024
    s_lshl_b32 s78, s53, 7
    s_add_u32 s79, s78, 2048
    s_add_u32 s80, s78, 4096
    s_mov_b32 m0, 0
    s_sub_u32 s67, s60, 4644864
    buffer_load_dwordx4 v240, s[36:39], s67 offen offset:0 lds
    buffer_load_dwordx4 v241, s[36:39], s67 offen offset:1024 lds
    buffer_load_dwordx4 v242, s[36:39], s67 offen offset:2048 lds
    buffer_load_dwordx4 v243, s[36:39], s67 offen offset:3072 lds
    s_mov_b32 m0, 4096
    s_sub_u32 s67, s60, 4534272
    buffer_load_dwordx4 v240, s[36:39], s67 offen offset:0 lds
    buffer_load_dwordx4 v241, s[36:39], s67 offen offset:1024 lds
    buffer_load_dwordx4 v242, s[36:39], s67 offen offset:2048 lds
    buffer_load_dwordx4 v243, s[36:39], s67 offen offset:3072 lds
    s_mov_b32 m0, 40960
    s_sub_u32 s67, s60, 3096576
    buffer_load_dwordx4 v240, s[36:39], s67 offen offset:0 lds
    buffer_load_dwordx4 v241, s[36:39], s67 offen offset:1024 lds
    buffer_load_dwordx4 v242, s[36:39], s67 offen offset:2048 lds
    buffer_load_dwordx4 v243, s[36:39], s67 offen offset:3072 lds
    s_mov_b32 m0, 45056
    s_sub_u32 s67, s60, 2985984
    buffer_load_dwordx4 v240, s[36:39], s67 offen offset:0 lds
    buffer_load_dwordx4 v241, s[36:39], s67 offen offset:1024 lds
    buffer_load_dwordx4 v242, s[36:39], s67 offen offset:2048 lds
    buffer_load_dwordx4 v243, s[36:39], s67 offen offset:3072 lds
    s_mov_b32 m0, 81920
    s_sub_u32 s67, s60, 1548288
    buffer_load_dwordx4 v240, s[36:39], s67 offen offset:0 lds
    buffer_load_dwordx4 v241, s[36:39], s67 offen offset:1024 lds
    buffer_load_dwordx4 v242, s[36:39], s67 offen offset:2048 lds
    buffer_load_dwordx4 v243, s[36:39], s67 offen offset:3072 lds
    s_mov_b32 m0, 86016
    s_sub_u32 s67, s60, 1437696
    buffer_load_dwordx4 v240, s[36:39], s67 offen offset:0 lds
    buffer_load_dwordx4 v241, s[36:39], s67 offen offset:1024 lds
    buffer_load_dwordx4 v242, s[36:39], s67 offen offset:2048 lds
    buffer_load_dwordx4 v243, s[36:39], s67 offen offset:3072 lds
    s_mov_b32 m0, 122880
    s_sub_u32 s67, s60, 0
    buffer_load_dwordx4 v240, s[36:39], s67 offen offset:0 lds
    buffer_load_dwordx4 v241, s[36:39], s67 offen offset:1024 lds
    buffer_load_dwordx4 v242, s[36:39], s67 offen offset:2048 lds
    buffer_load_dwordx4 v243, s[36:39], s67 offen offset:3072 lds
    s_mov_b32 m0, 126976
    s_add_u32 s67, s60, 110592
    buffer_load_dwordx4 v240, s[36:39], s67 offen offset:0 lds
    buffer_load_dwordx4 v241, s[36:39], s67 offen offset:1024 lds
    buffer_load_dwordx4 v242, s[36:39], s67 offen offset:2048 lds
    buffer_load_dwordx4 v243, s[36:39], s67 offen offset:3072 lds
    s_mov_b32 m0, 8192
    s_sub_u32 s67, s61, 4644864
    buffer_load_dwordx4 v240, s[36:39], s67 offen offset:0 lds
    buffer_load_dwordx4 v241, s[36:39], s67 offen offset:1024 lds
    buffer_load_dwordx4 v242, s[36:39], s67 offen offset:2048 lds
    buffer_load_dwordx4 v243, s[36:39], s67 offen offset:3072 lds
    s_mov_b32 m0, 12288
    s_sub_u32 s67, s61, 4534272
    buffer_load_dwordx4 v240, s[36:39], s67 offen offset:0 lds
    buffer_load_dwordx4 v241, s[36:39], s67 offen offset:1024 lds
    buffer_load_dwordx4 v242, s[36:39], s67 offen offset:2048 lds
    buffer_load_dwordx4 v243, s[36:39], s67 offen offset:3072 lds
    s_mov_b32 m0, 49152
    s_sub_u32 s67, s61, 3096576
    buffer_load_dwordx4 v240, s[36:39], s67 offen offset:0 lds
    buffer_load_dwordx4 v241, s[36:39], s67 offen offset:1024 lds
    buffer_load_dwordx4 v242, s[36:39], s67 offen offset:2048 lds
    buffer_load_dwordx4 v243, s[36:39], s67 offen offset:3072 lds
    s_mov_b32 m0, 53248
    s_sub_u32 s67, s61, 2985984
    buffer_load_dwordx4 v240, s[36:39], s67 offen offset:0 lds
    buffer_load_dwordx4 v241, s[36:39], s67 offen offset:1024 lds
    buffer_load_dwordx4 v242, s[36:39], s67 offen offset:2048 lds
    buffer_load_dwordx4 v243, s[36:39], s67 offen offset:3072 lds
    s_mov_b32 m0, 90112
    s_sub_u32 s67, s61, 1548288
    buffer_load_dwordx4 v240, s[36:39], s67 offen offset:0 lds
    buffer_load_dwordx4 v241, s[36:39], s67 offen offset:1024 lds
    buffer_load_dwordx4 v242, s[36:39], s67 offen offset:2048 lds
    buffer_load_dwordx4 v243, s[36:39], s67 offen offset:3072 lds
    s_mov_b32 m0, 94208
    s_sub_u32 s67, s61, 1437696
    buffer_load_dwordx4 v240, s[36:39], s67 offen offset:0 lds
    buffer_load_dwordx4 v241, s[36:39], s67 offen offset:1024 lds
    buffer_load_dwordx4 v242, s[36:39], s67 offen offset:2048 lds
    buffer_load_dwordx4 v243, s[36:39], s67 offen offset:3072 lds
    s_waitcnt vmcnt(52)
    s_mov_b32 m0, 131072
    s_sub_u32 s67, s61, 0
    buffer_load_dwordx4 v240, s[36:39], s67 offen offset:0 lds
    buffer_load_dwordx4 v241, s[36:39], s67 offen offset:1024 lds
    buffer_load_dwordx4 v242, s[36:39], s67 offen offset:2048 lds
    buffer_load_dwordx4 v243, s[36:39], s67 offen offset:3072 lds
    s_mov_b32 m0, 135168
    s_add_u32 s67, s61, 110592
    buffer_load_dwordx4 v240, s[36:39], s67 offen offset:0 lds
    buffer_load_dwordx4 v241, s[36:39], s67 offen offset:1024 lds
    buffer_load_dwordx4 v242, s[36:39], s67 offen offset:2048 lds
    buffer_load_dwordx4 v243, s[36:39], s67 offen offset:3072 lds
    s_waitcnt vmcnt(52)
    s_mov_b32 m0, 16384
    s_sub_u32 s67, s62, 4644864
    buffer_load_dwordx4 v240, s[36:39], s67 offen offset:0 lds
    buffer_load_dwordx4 v241, s[36:39], s67 offen offset:1024 lds
    buffer_load_dwordx4 v242, s[36:39], s67 offen offset:2048 lds
    buffer_load_dwordx4 v243, s[36:39], s67 offen offset:3072 lds
    s_mov_b32 m0, 20480
    s_sub_u32 s67, s62, 4534272
    buffer_load_dwordx4 v240, s[36:39], s67 offen offset:0 lds
    buffer_load_dwordx4 v241, s[36:39], s67 offen offset:1024 lds
    buffer_load_dwordx4 v242, s[36:39], s67 offen offset:2048 lds
    buffer_load_dwordx4 v243, s[36:39], s67 offen offset:3072 lds
    s_waitcnt vmcnt(52)
    s_mov_b32 m0, 57344
    s_sub_u32 s67, s62, 3096576
    buffer_load_dwordx4 v240, s[36:39], s67 offen offset:0 lds
    buffer_load_dwordx4 v241, s[36:39], s67 offen offset:1024 lds
    buffer_load_dwordx4 v242, s[36:39], s67 offen offset:2048 lds
    buffer_load_dwordx4 v243, s[36:39], s67 offen offset:3072 lds
    s_mov_b32 m0, 61440
    s_sub_u32 s67, s62, 2985984
    buffer_load_dwordx4 v240, s[36:39], s67 offen offset:0 lds
    buffer_load_dwordx4 v241, s[36:39], s67 offen offset:1024 lds
    buffer_load_dwordx4 v242, s[36:39], s67 offen offset:2048 lds
    buffer_load_dwordx4 v243, s[36:39], s67 offen offset:3072 lds
    s_waitcnt vmcnt(52)
    s_mov_b32 m0, 98304
    s_sub_u32 s67, s62, 1548288
    buffer_load_dwordx4 v240, s[36:39], s67 offen offset:0 lds
    buffer_load_dwordx4 v241, s[36:39], s67 offen offset:1024 lds
    buffer_load_dwordx4 v242, s[36:39], s67 offen offset:2048 lds
    buffer_load_dwordx4 v243, s[36:39], s67 offen offset:3072 lds
    s_mov_b32 m0, 102400
    s_sub_u32 s67, s62, 1437696
    buffer_load_dwordx4 v240, s[36:39], s67 offen offset:0 lds
    buffer_load_dwordx4 v241, s[36:39], s67 offen offset:1024 lds
    buffer_load_dwordx4 v242, s[36:39], s67 offen offset:2048 lds
    buffer_load_dwordx4 v243, s[36:39], s67 offen offset:3072 lds
    s_waitcnt vmcnt(52)
    s_mov_b32 m0, 139264
    s_sub_u32 s67, s62, 0
    buffer_load_dwordx4 v240, s[36:39], s67 offen offset:0 lds
    buffer_load_dwordx4 v241, s[36:39], s67 offen offset:1024 lds
    buffer_load_dwordx4 v242, s[36:39], s67 offen offset:2048 lds
    buffer_load_dwordx4 v243, s[36:39], s67 offen offset:3072 lds
    s_mov_b32 m0, 143360
    s_add_u32 s67, s62, 110592
    buffer_load_dwordx4 v240, s[36:39], s67 offen offset:0 lds
    buffer_load_dwordx4 v241, s[36:39], s67 offen offset:1024 lds
    buffer_load_dwordx4 v242, s[36:39], s67 offen offset:2048 lds
    buffer_load_dwordx4 v243, s[36:39], s67 offen offset:3072 lds
    s_waitcnt vmcnt(52)
    s_mov_b32 m0, 24576
    s_sub_u32 s67, s63, 4644864
    buffer_load_dwordx4 v240, s[36:39], s67 offen offset:0 lds
    buffer_load_dwordx4 v241, s[36:39], s67 offen offset:1024 lds
    buffer_load_dwordx4 v242, s[36:39], s67 offen offset:2048 lds
    buffer_load_dwordx4 v243, s[36:39], s67 offen offset:3072 lds
    s_mov_b32 m0, 28672
    s_sub_u32 s67, s63, 4534272
    buffer_load_dwordx4 v240, s[36:39], s67 offen offset:0 lds
    buffer_load_dwordx4 v241, s[36:39], s67 offen offset:1024 lds
    buffer_load_dwordx4 v242, s[36:39], s67 offen offset:2048 lds
    buffer_load_dwordx4 v243, s[36:39], s67 offen offset:3072 lds
    s_waitcnt vmcnt(52)
    s_load_dword s87, s[88:89], 0
    s_mov_b32 m0, 65536
    s_sub_u32 s67, s63, 3096576
    buffer_load_dwordx4 v240, s[36:39], s67 offen offset:0 lds
    buffer_load_dwordx4 v241, s[36:39], s67 offen offset:1024 lds
    buffer_load_dwordx4 v242, s[36:39], s67 offen offset:2048 lds
    buffer_load_dwordx4 v243, s[36:39], s67 offen offset:3072 lds
    s_mov_b32 m0, 69632
    s_sub_u32 s67, s63, 2985984
    buffer_load_dwordx4 v240, s[36:39], s67 offen offset:0 lds
    buffer_load_dwordx4 v241, s[36:39], s67 offen offset:1024 lds
    buffer_load_dwordx4 v242, s[36:39], s67 offen offset:2048 lds
    buffer_load_dwordx4 v243, s[36:39], s67 offen offset:3072 lds
    s_waitcnt vmcnt(52)
    s_mov_b32 m0, 106496
    s_sub_u32 s67, s63, 1548288
    buffer_load_dwordx4 v240, s[36:39], s67 offen offset:0 lds
    buffer_load_dwordx4 v241, s[36:39], s67 offen offset:1024 lds
    buffer_load_dwordx4 v242, s[36:39], s67 offen offset:2048 lds
    buffer_load_dwordx4 v243, s[36:39], s67 offen offset:3072 lds
    s_mov_b32 m0, 110592
    s_sub_u32 s67, s63, 1437696
    buffer_load_dwordx4 v240, s[36:39], s67 offen offset:0 lds
    buffer_load_dwordx4 v241, s[36:39], s67 offen offset:1024 lds
    buffer_load_dwordx4 v242, s[36:39], s67 offen offset:2048 lds
    buffer_load_dwordx4 v243, s[36:39], s67 offen offset:3072 lds
    s_waitcnt vmcnt(52)
    s_mov_b32 m0, 147456
    s_sub_u32 s67, s63, 0
    buffer_load_dwordx4 v240, s[36:39], s67 offen offset:0 lds
    buffer_load_dwordx4 v241, s[36:39], s67 offen offset:1024 lds
    buffer_load_dwordx4 v242, s[36:39], s67 offen offset:2048 lds
    buffer_load_dwordx4 v243, s[36:39], s67 offen offset:3072 lds
    s_mov_b32 m0, 151552
    s_add_u32 s67, s63, 110592
    buffer_load_dwordx4 v240, s[36:39], s67 offen offset:0 lds
    buffer_load_dwordx4 v241, s[36:39], s67 offen offset:1024 lds
    buffer_load_dwordx4 v242, s[36:39], s67 offen offset:2048 lds
    buffer_load_dwordx4 v243, s[36:39], s67 offen offset:3072 lds
    s_waitcnt vmcnt(52)
    s_waitcnt lgkmcnt(0)
    s_cmp_lg_u32 s87, 0
    s_cbranch_scc1 Ltk_11
    s_mov_b32 s86, 0
    v_mov_b32 v15, 0
Ltk_10:
    buffer_load_dword v14, v15, s[88:91], 0 offen sc0 sc1
    s_add_u32 s86, s86, 1
    s_cmp_gt_u32 s86, 524288
    s_cbranch_scc1 Lend_1
    s_waitcnt vmcnt(0)
    v_readfirstlane_b32 s87, v14
    s_nop 3
    s_cmp_lg_u32 s87, 0
    s_cbranch_scc0 Ltk_10
Ltk_11:
    v_mov_b32 v14, s87
    v_lshlrev_b32 v15, 2, v0
    v_and_b32 v1, 32, v0
    v_lshl_add_u32 v15, v1, 24, v15
    s_waitcnt vmcnt(63)
    s_barrier
    ds_read_b64_tr_b16 a[0:1], v10 offset:0
    ds_read_b64_tr_b16 a[2:3], v10 offset:4096
    ds_read_b64_tr_b16 a[4:5], v11 offset:0
    ds_read_b64_tr_b16 a[6:7], v11 offset:4096
    ds_read_b64_tr_b16 a[8:9], v12 offset:0
    ds_read_b64_tr_b16 a[10:11], v12 offset:4096
    ds_read_b64_tr_b16 a[12:13], v13 offset:0
    ds_read_b64_tr_b16 a[14:15], v13 offset:4096
    ds_read_b64_tr_b16 a[16:17], v10 offset:2048
    ds_read_b64_tr_b16 a[18:19], v10 offset:6144
    ds_read_b64_tr_b16 a[20:21], v11 offset:2048
    ds_read_b64_tr_b16 a[22:23], v11 offset:6144
    ds_read_b64_tr_b16 a[24:25], v12 offset:2048
    ds_read_b64_tr_b16 a[26:27], v12 offset:6144
    ds_read_b64_tr_b16 a[28:29], v13 offset:2048
    ds_read_b64_tr_b16 a[30:31], v13 offset:6144
    ds_read_b64_tr_b16 a[32:33], v10 offset:8192
    ds_read_b64_tr_b16 a[34:35], v10 offset:12288
    ds_read_b64_tr_b16 a[36:37], v11 offset:8192
    ds_read_b64_tr_b16 a[38:39], v11 offset:12288
    ds_read_b64_tr_b16 a[40:41], v12 offset:8192
    ds_read_b64_tr_b16 a[42:43], v12 offset:12288
    ds_read_b64_tr_b16 a[44:45], v13 offset:8192
    ds_read_b64_tr_b16 a[46:47], v13 offset:12288
    ds_read_b64_tr_b16 a[48:49], v10 offset:10240
    ds_read_b64_tr_b16 a[50:51], v10 offset:14336
    ds_read_b64_tr_b16 a[52:53], v11 offset:10240
    ds_read_b64_tr_b16 a[54:55], v11 offset:14336
    ds_read_b64_tr_b16 a[56:57], v12 offset:10240
    ds_read_b64_tr_b16 a[58:59], v12 offset:14336
    ds_read_b64_tr_b16 a[60:61], v13 offset:10240
    ds_read_b64_tr_b16 a[62:63], v13 offset:14336
    s_mov_b32 m0, 32768
    s_sub_u32 s67, s64, 4644864
    buffer_load_dwordx4 v240, s[36:39], s67 offen offset:0 lds
    buffer_load_dwordx4 v241, s[36:39], s67 offen offset:1024 lds
    buffer_load_dwordx4 v242, s[36:39], s67 offen offset:2048 lds
    buffer_load_dwordx4 v243, s[36:39], s67 offen offset:3072 lds
    s_mov_b32 m0, 36864
    s_sub_u32 s67, s64, 4534272
    buffer_load_dwordx4 v240, s[36:39], s67 offen offset:0 lds
    buffer_load_dwordx4 v241, s[36:39], s67 offen offset:1024 lds
    buffer_load_dwordx4 v242, s[36:39], s67 offen offset:2048 lds
    buffer_load_dwordx4 v243, s[36:39], s67 offen offset:3072 lds
    s_mov_b32 m0, 73728
    s_sub_u32 s67, s64, 3096576
    buffer_load_dwordx4 v240, s[36:39], s67 offen offset:0 lds
    buffer_load_dwordx4 v241, s[36:39], s67 offen offset:1024 lds
    buffer_load_dwordx4 v242, s[36:39], s67 offen offset:2048 lds
    buffer_load_dwordx4 v243, s[36:39], s67 offen offset:3072 lds
    s_mov_b32 m0, 77824
    s_sub_u32 s67, s64, 2985984
    buffer_load_dwordx4 v240, s[36:39], s67 offen offset:0 lds
    buffer_load_dwordx4 v241, s[36:39], s67 offen offset:1024 lds
    buffer_load_dwordx4 v242, s[36:39], s67 offen offset:2048 lds
    buffer_load_dwordx4 v243, s[36:39], s67 offen offset:3072 lds
    s_mov_b32 m0, 114688
    s_sub_u32 s67, s64, 1548288
    buffer_load_dwordx4 v240, s[36:39], s67 offen offset:0 lds
    buffer_load_dwordx4 v241, s[36:39], s67 offen offset:1024 lds
    buffer_load_dwordx4 v242, s[36:39], s67 offen offset:2048 lds
    buffer_load_dwordx4 v243, s[36:39], s67 offen offset:3072 lds
    s_mov_b32 m0, 118784
    s_sub_u32 s67, s64, 1437696
    buffer_load_dwordx4 v240, s[36:39], s67 offen offset:0 lds
    buffer_load_dwordx4 v241, s[36:39], s67 offen offset:1024 lds
    buffer_load_dwordx4 v242, s[36:39], s67 offen offset:2048 lds
    buffer_load_dwordx4 v243, s[36:39], s67 offen offset:3072 lds
    s_mov_b32 m0, 155648
    s_sub_u32 s67, s64, 0
    buffer_load_dwordx4 v240, s[36:39], s67 offen offset:0 lds
    buffer_load_dwordx4 v241, s[36:39], s67 offen offset:1024 lds
    buffer_load_dwordx4 v242, s[36:39], s67 offen offset:2048 lds
    buffer_load_dwordx4 v243, s[36:39], s67 offen offset:3072 lds
    s_mov_b32 m0, 159744
    s_add_u32 s67, s64, 110592
    buffer_load_dwordx4 v240, s[36:39], s67 offen offset:0 lds
    buffer_load_dwordx4 v241, s[36:39], s67 offen offset:1024 lds
    buffer_load_dwordx4 v242, s[36:39], s67 offen offset:2048 lds
    buffer_load_dwordx4 v243, s[36:39], s67 offen offset:3072 lds
    s_waitcnt lgkmcnt(0)
    s_barrier
    s_mov_b32 m0, 0
    s_sub_u32 s67, s65, 4644864
    buffer_load_dwordx4 v240, s[36:39], s67 offen offset:0 lds
    buffer_load_dwordx4 v241, s[36:39], s67 offen offset:1024 lds
    buffer_load_dwordx4 v242, s[36:39], s67 offen offset:2048 lds
    buffer_load_dwordx4 v243, s[36:39], s67 offen offset:3072 lds
    s_mov_b32 m0, 4096
    s_sub_u32 s67, s65, 4534272
    buffer_load_dwordx4 v240, s[36:39], s67 offen offset:0 lds
    buffer_load_dwordx4 v241, s[36:39], s67 offen offset:1024 lds
    buffer_load_dwordx4 v242, s[36:39], s67 offen offset:2048 lds
    buffer_load_dwordx4 v243, s[36:39], s67 offen offset:3072 lds
    s_mov_b32 m0, 40960
    s_sub_u32 s67, s65, 3096576
    buffer_load_dwordx4 v240, s[36:39], s67 offen offset:0 lds
    buffer_load_dwordx4 v241, s[36:39], s67 offen offset:1024 lds
    buffer_load_dwordx4 v242, s[36:39], s67 offen offset:2048 lds
    buffer_load_dwordx4 v243, s[36:39], s67 offen offset:3072 lds
    s_mov_b32 m0, 45056
    s_sub_u32 s67, s65, 2985984
    buffer_load_dwordx4 v240, s[36:39], s67 offen offset:0 lds
    buffer_load_dwordx4 v241, s[36:39], s67 offen offset:1024 lds
    buffer_load_dwordx4 v242, s[36:39], s67 offen offset:2048 lds
    buffer_load_dwordx4 v243, s[36:39], s67 offen offset:3072 lds
    s_mov_b32 m0, 81920
    s_sub_u32 s67, s65, 1548288
    buffer_load_dwordx4 v240, s[36:39], s67 offen offset:0 lds
    buffer_load_dwordx4 v241, s[36:39], s67 offen offset:1024 lds
    buffer_load_dwordx4 v242, s[36:39], s67 offen offset:2048 lds
    buffer_load_dwordx4 v243, s[36:39], s67 offen offset:3072 lds
    s_mov_b32 m0, 86016
    s_sub_u32 s67, s65, 1437696
    buffer_load_dwordx4 v240, s[36:39], s67 offen offset:0 lds
    buffer_load_dwordx4 v241, s[36:39], s67 offen offset:1024 lds
    buffer_load_dwordx4 v242, s[36:39], s67 offen offset:2048 lds
    buffer_load_dwordx4 v243, s[36:39], s67 offen offset:3072 lds
    s_mov_b32 m0, 122880
    s_sub_u32 s67, s65, 0
    buffer_load_dwordx4 v240, s[36:39], s67 offen offset:0 lds
    buffer_load_dwordx4 v241, s[36:39], s67 offen offset:1024 lds
    buffer_load_dwordx4 v242, s[36:39], s67 offen offset:2048 lds
    buffer_load_dwordx4 v243, s[36:39], s67 offen offset:3072 lds
    s_mov_b32 m0, 126976
    s_add_u32 s67, s65, 110592
    buffer_load_dwordx4 v240, s[36:39], s67 offen offset:0 lds
    buffer_load_dwordx4 v241, s[36:39], s67 offen offset:1024 lds
    buffer_load_dwordx4 v242, s[36:39], s67 offen offset:2048 lds
    buffer_load_dwordx4 v243, s[36:39], s67 offen offset:3072 lds
    buffer_load_dword v8, v9, s[44:47], s75 offen offset:0 sc0 sc1
    s_mov_b32 m0, 8192
    s_sub_u32 s67, s66, 4644864
    buffer_load_dwordx4 v240, s[36:39], s67 offen offset:0 lds
    buffer_load_dwordx4 v241, s[36:39], s67 offen offset:1024 lds
    buffer_load_dwordx4 v242, s[36:39], s67 offen offset:2048 lds
    buffer_load_dwordx4 v243, s[36:39], s67 offen offset:3072 lds
    s_mov_b32 m0, 12288
    s_sub_u32 s67, s66, 4534272
    buffer_load_dwordx4 v240, s[36:39], s67 offen offset:0 lds
    buffer_load_dwordx4 v241, s[36:39], s67 offen offset:1024 lds
    buffer_load_dwordx4 v242, s[36:39], s67 offen offset:2048 lds
    buffer_load_dwordx4 v243, s[36:39], s67 offen offset:3072 lds
    s_mov_b32 m0, 49152
    s_sub_u32 s67, s66, 3096576
    buffer_load_dwordx4 v240, s[36:39], s67 offen offset:0 lds
    buffer_load_dwordx4 v241, s[36:39], s67 offen offset:1024 lds
    buffer_load_dwordx4 v242, s[36:39], s67 offen offset:2048 lds
    buffer_load_dwordx4 v243, s[36:39], s67 offen offset:3072 lds
    s_mov_b32 m0, 53248
    s_sub_u32 s67, s66, 2985984
    buffer_load_dwordx4 v240, s[36:39], s67 offen offset:0 lds
    buffer_load_dwordx4 v241, s[36:39], s67 offen offset:1024 lds
    buffer_load_dwordx4 v242, s[36:39], s67 offen offset:2048 lds
    buffer_load_dwordx4 v243, s[36:39], s67 offen offset:3072 lds
    s_mov_b32 m0, 90112
    s_sub_u32 s67, s66, 1548288
    buffer_load_dwordx4 v240, s[36:39], s67 offen offset:0 lds
    buffer_load_dwordx4 v241, s[36:39], s67 offen offset:1024 lds
    buffer_load_dwordx4 v242, s[36:39], s67 offen offset:2048 lds
    buffer_load_dwordx4 v243, s[36:39], s67 offen offset:3072 lds
    s_mov_b32 m0, 94208
    s_sub_u32 s67, s66, 1437696
    buffer_load_dwordx4 v240, s[36:39], s67 offen offset:0 lds
    buffer_load_dwordx4 v241, s[36:39], s67 offen offset:1024 lds
    buffer_load_dwordx4 v242, s[36:39], s67 offen offset:2048 lds
    buffer_load_dwordx4 v243, s[36:39], s67 offen offset:3072 lds
    s_mov_b32 m0, 131072
    s_sub_u32 s67, s66, 0
    buffer_load_dwordx4 v240, s[36:39], s67 offen offset:0 lds
    buffer_load_dwordx4 v241, s[36:39], s67 offen offset:1024 lds
    buffer_load_dwordx4 v242, s[36:39], s67 offen offset:2048 lds
    buffer_load_dwordx4 v243, s[36:39], s67 offen offset:3072 lds
    s_mov_b32 m0, 135168
    s_add_u32 s67, s66, 110592
    buffer_load_dwordx4 v240, s[36:39], s67 offen offset:0 lds
    buffer_load_dwordx4 v241, s[36:39], s67 offen offset:1024 lds
    buffer_load_dwordx4 v242, s[36:39], s67 offen offset:2048 lds
    buffer_load_dwordx4 v243, s[36:39], s67 offen offset:3072 lds
    s_waitcnt vmcnt(32)
    s_branch Lj3_12
Lb1_7:
    s_barrier
    ds_read_b64_tr_b16 a[0:1], v10 offset:0
    ds_read_b64_tr_b16 a[2:3], v10 offset:4096
    ds_read_b64_tr_b16 a[4:5], v11 offset:0
    ds_read_b64_tr_b16 a[6:7], v11 offset:4096
    ds_read_b64_tr_b16 a[8:9], v12 offset:0
    ds_read_b64_tr_b16 a[10:11], v12 offset:4096
    ds_read_b64_tr_b16 a[12:13], v13 offset:0
    ds_read_b64_tr_b16 a[14:15], v13 offset:4096
    ds_read_b64_tr_b16 a[16:17], v10 offset:2048
    ds_read_b64_tr_b16 a[18:19], v10 offset:6144
    ds_read_b64_tr_b16 a[20:21], v11 offset:2048
    ds_read_b64_tr_b16 a[22:23], v11 offset:6144
    ds_read_b64_tr_b16 a[24:25], v12 offset:2048
    ds_read_b64_tr_b16 a[26:27], v12 offset:6144
    ds_read_b64_tr_b16 a[28:29], v13 offset:2048
    ds_read_b64_tr_b16 a[30:31], v13 offset:6144
    ds_read_b64_tr_b16 a[32:33], v10 offset:8192
    ds_read_b64_tr_b16 a[34:35], v10 offset:12288
    ds_read_b64_tr_b16 a[36:37], v11 offset:8192
    ds_read_b64_tr_b16 a[38:39], v11 offset:12288
    ds_read_b64_tr_b16 a[40:41], v12 offset:8192
    ds_read_b64_tr_b16 a[42:43], v12 offset:12288
    ds_read_b64_tr_b16 a[44:45], v13 offset:8192
    ds_read_b64_tr_b16 a[46:47], v13 offset:12288
    ds_read_b64_tr_b16 a[48:49], v10 offset:10240
    ds_read_b64_tr_b16 a[50:51], v10 offset:14336
    ds_read_b64_tr_b16 a[52:53], v11 offset:10240
    ds_read_b64_tr_b16 a[54:55], v11 offset:14336
    ds_read_b64_tr_b16 a[56:57], v12 offset:10240
    ds_read_b64_tr_b16 a[58:59], v12 offset:14336
    ds_read_b64_tr_b16 a[60:61], v13 offset:10240
    ds_read_b64_tr_b16 a[62:63], v13 offset:14336
    s_waitcnt lgkmcnt(0)
    s_barrier
    buffer_load_dword v8, v9, s[44:47], s75 offen offset:0 sc0 sc1
    s_waitcnt vmcnt(0)
Lj3_12:
    s_waitcnt vmcnt(63)
    v_cmp_ne_u32 vcc, s87, v8
    s_mov_b32 s86, 0
    s_nop 3
    s_cbranch_vccz Lp_14
Lp_13:
    buffer_load_dword v8, v9, s[44:47], s75 offen offset:0 sc0 sc1
    s_add_u32 s86, s86, 1
    s_cmp_gt_u32 s86, 524288
    s_cbranch_scc1 Lend_1
    s_waitcnt vmcnt(0)
    v_cmp_ne_u32 vcc, s87, v8
    s_nop 4
    s_cbranch_vccnz Lp_13
Lp_14:
    buffer_load_dwordx4 v[80:83], v4, s[40:43], s68 offen offset:0 sc1
    buffer_load_dwordx4 v[84:87], v4, s[40:43], s68 offen offset:1024 sc1
    buffer_load_dwordx4 v[88:91], v4, s[40:43], s68 offen offset:2048 sc1
    buffer_load_dwordx4 v[92:95], v4, s[40:43], s68 offen offset:3072 sc1
    buffer_load_dwordx4 v[96:99], v4, s[40:43], s69 offen offset:0 sc1
    buffer_load_dwordx4 v[100:103], v4, s[40:43], s69 offen offset:1024 sc1
    buffer_load_dwordx4 v[104:107], v4, s[40:43], s69 offen offset:2048 sc1
    buffer_load_dwordx4 v[108:111], v4, s[40:43], s69 offen offset:3072 sc1
    buffer_load_dwordx4 v[112:115], v4, s[40:43], s70 offen offset:0 sc1
    buffer_load_dwordx4 v[116:119], v4, s[40:43], s70 offen offset:1024 sc1
    buffer_load_dwordx4 v[120:123], v4, s[40:43], s70 offen offset:2048 sc1
    buffer_load_dwordx4 v[124:127], v4, s[40:43], s70 offen offset:3072 sc1
    buffer_load_dwordx4 v[128:131], v4, s[40:43], s71 offen offset:0 sc1
    buffer_load_dwordx4 v[132:135], v4, s[40:43], s71 offen offset:1024 sc1
    s_waitcnt lgkmcnt(0)
    s_waitcnt vmcnt(14)
    s_barrier
    s_waitcnt vmcnt(12)
    v_mfma_f32_16x16x32_bf16 v[16:19], v[80:83], a[0:3], 0
    ds_read_b64_tr_b16 a[64:65], v10 offset:16384
    v_mfma_f32_16x16x32_bf16 v[20:23], v[80:83], a[4:7], 0
    buffer_load_dwordx4 v[136:139], v4, s[40:43], s71 offen offset:2048 sc1
    ds_read_b64_tr_b16 a[66:67], v10 offset:20480
    v_mfma_f32_16x16x32_bf16 v[24:27], v[80:83], a[8:11], 0
    ds_read_b64_tr_b16 a[68:69], v11 offset:16384
    v_mfma_f32_16x16x32_bf16 v[28:31], v[80:83], a[12:15], 0
    ds_read_b64_tr_b16 a[70:71], v11 offset:20480
    v_mfma_f32_16x16x32_bf16 v[16:19], v[84:87], a[16:19], v[16:19]
    ds_read_b64_tr_b16 a[72:73], v12 offset:16384
    v_mfma_f32_16x16x32_bf16 v[20:23], v[84:87], a[20:23], v[20:23]
    buffer_load_dwordx4 v[140:143], v4, s[40:43], s71 offen offset:3072 sc1
    ds_read_b64_tr_b16 a[74:75], v12 offset:20480
    v_mfma_f32_16x16x32_bf16 v[24:27], v[84:87], a[24:27], v[24:27]
    ds_read_b64_tr_b16 a[76:77], v13 offset:16384
    v_mfma_f32_16x16x32_bf16 v[28:31], v[84:87], a[28:31], v[28:31]
    ds_read_b64_tr_b16 a[78:79], v13 offset:20480
    s_waitcnt vmcnt(12)
    v_mfma_f32_16x16x32_bf16 v[32:35], v[88:91], a[0:3], 0
    ds_read_b64_tr_b16 a[80:81], v10 offset:18432
    v_mfma_f32_16x16x32_bf16 v[36:39], v[88:91], a[4:7], 0
    buffer_load_dwordx4 v[144:147], v4, s[40:43], s72 offen offset:0 sc1
    ds_read_b64_tr_b16 a[82:83], v10 offset:22528
    v_mfma_f32_16x16x32_bf16 v[40:43], v[88:91], a[8:11], 0
    ds_read_b64_tr_b16 a[84:85], v11 offset:18432
    v_mfma_f32_16x16x32_bf16 v[44:47], v[88:91], a[12:15], 0
    ds_read_b64_tr_b16 a[86:87], v11 offset:22528
    v_mfma_f32_16x16x32_bf16 v[32:35], v[92:95], a[16:19], v[32:35]
    ds_read_b64_tr_b16 a[88:89], v12 offset:18432
    v_mfma_f32_16x16x32_bf16 v[36:39], v[92:95], a[20:23], v[36:39]
    buffer_load_dwordx4 v[148:151], v4, s[40:43], s72 offen offset:1024 sc1
    ds_read_b64_tr_b16 a[90:91], v12 offset:22528
    v_mfma_f32_16x16x32_bf16 v[40:43], v[92:95], a[24:27], v[40:43]
    ds_read_b64_tr_b16 a[92:93], v13 offset:18432
    v_mfma_f32_16x16x32_bf16 v[44:47], v[92:95], a[28:31], v[44:47]
    ds_read_b64_tr_b16 a[94:95], v13 offset:22528
    s_waitcnt vmcnt(12)
    v_mfma_f32_16x16x32_bf16 v[16:19], v[96:99], a[32:35], v[16:19]
    ds_read_b64_tr_b16 a[96:97], v10 offset:24576
    v_mfma_f32_16x16x32_bf16 v[20:23], v[96:99], a[36:39], v[20:23]
    buffer_load_dwordx4 v[152:155], v4, s[40:43], s72 offen offset:2048 sc1
    ds_read_b64_tr_b16 a[98:99], v10 offset:28672
    v_mfma_f32_16x16x32_bf16 v[24:27], v[96:99], a[40:43], v[24:27]
    ds_read_b64_tr_b16 a[100:101], v11 offset:24576
    v_mfma_f32_16x16x32_bf16 v[28:31], v[96:99], a[44:47], v[28:31]
    ds_read_b64_tr_b16 a[102:103], v11 offset:28672
    v_mfma_f32_16x16x32_bf16 v[16:19], v[100:103], a[48:51], v[16:19]
    ds_read_b64_tr_b16 a[104:105], v12 offset:24576
    v_mfma_f32_16x16x32_bf16 v[20:23], v[100:103], a[52:55], v[20:23]
    buffer_load_dwordx4 v[156:159], v4, s[40:43], s72 offen offset:3072 sc1
    ds_read_b64_tr_b16 a[106:107], v12 offset:28672
    v_mfma_f32_16x16x32_bf16 v[24:27], v[100:103], a[56:59], v[24:27]
    ds_read_b64_tr_b16 a[108:109], v13 offset:24576
    v_mfma_f32_16x16x32_bf16 v[28:31], v[100:103], a[60:63], v[28:31]
    ds_read_b64_tr_b16 a[110:111], v13 offset:28672
    s_waitcnt vmcnt(12)
    v_mfma_f32_16x16x32_bf16 v[32:35], v[104:107], a[32:35], v[32:35]
    ds_read_b64_tr_b16 a[112:113], v10 offset:26624
    v_mfma_f32_16x16x32_bf16 v[36:39], v[104:107], a[36:39], v[36:39]
    buffer_load_dwordx4 v[160:163], v4, s[40:43], s73 offen offset:0 sc1
    ds_read_b64_tr_b16 a[114:115], v10 offset:30720
    v_mfma_f32_16x16x32_bf16 v[40:43], v[104:107], a[40:43], v[40:43]
    ds_read_b64_tr_b16 a[116:117], v11 offset:26624
    v_mfma_f32_16x16x32_bf16 v[44:47], v[104:107], a[44:47], v[44:47]
    ds_read_b64_tr_b16 a[118:119], v11 offset:30720
    v_mfma_f32_16x16x32_bf16 v[32:35], v[108:111], a[48:51], v[32:35]
    ds_read_b64_tr_b16 a[120:121], v12 offset:26624
    v_mfma_f32_16x16x32_bf16 v[36:39], v[108:111], a[52:55], v[36:39]
    buffer_load_dwordx4 v[164:167], v4, s[40:43], s73 offen offset:1024 sc1
    ds_read_b64_tr_b16 a[122:123], v12 offset:30720
    v_mfma_f32_16x16x32_bf16 v[40:43], v[108:111], a[56:59], v[40:43]
    ds_read_b64_tr_b16 a[124:125], v13 offset:26624
    v_mfma_f32_16x16x32_bf16 v[44:47], v[108:111], a[60:63], v[44:47]
    ds_read_b64_tr_b16 a[126:127], v13 offset:30720
    s_waitcnt lgkmcnt(15)
    s_waitcnt vmcnt(12)
    v_mfma_f32_16x16x32_bf16 v[16:19], v[112:115], a[64:67], v[16:19]
    ds_read_b64_tr_b16 a[128:129], v10 offset:32768
    v_mfma_f32_16x16x32_bf16 v[20:23], v[112:115], a[68:71], v[20:23]
    buffer_load_dwordx4 v[168:171], v4, s[40:43], s73 offen offset:2048 sc1
    ds_read_b64_tr_b16 a[130:131], v10 offset:36864
    v_mfma_f32_16x16x32_bf16 v[24:27], v[112:115], a[72:75], v[24:27]
    ds_read_b64_tr_b16 a[132:133], v11 offset:32768
    v_mfma_f32_16x16x32_bf16 v[28:31], v[112:115], a[76:79], v[28:31]
    ds_read_b64_tr_b16 a[134:135], v11 offset:36864
    v_mfma_f32_16x16x32_bf16 v[16:19], v[116:119], a[80:83], v[16:19]
    ds_read_b64_tr_b16 a[136:137], v12 offset:32768
    v_mfma_f32_16x16x32_bf16 v[20:23], v[116:119], a[84:87], v[20:23]
    buffer_load_dwordx4 v[172:175], v4, s[40:43], s73 offen offset:3072 sc1
    ds_read_b64_tr_b16 a[138:139], v12 offset:36864
    v_mfma_f32_16x16x32_bf16 v[24:27], v[116:119], a[88:91], v[24:27]
    ds_read_b64_tr_b16 a[140:141], v13 offset:32768
    v_mfma_f32_16x16x32_bf16 v[28:31], v[116:119], a[92:95], v[28:31]
    ds_read_b64_tr_b16 a[142:143], v13 offset:36864
    s_waitcnt vmcnt(12)
    v_mfma_f32_16x16x32_bf16 v[32:35], v[120:123], a[64:67], v[32:35]
    ds_read_b64_tr_b16 a[144:145], v10 offset:34816
    v_mfma_f32_16x16x32_bf16 v[36:39], v[120:123], a[68:71], v[36:39]
    buffer_load_dwordx4 v[176:179], v4, s[40:43], s74 offen offset:0 sc1
    ds_read_b64_tr_b16 a[146:147], v10 offset:38912
    v_mfma_f32_16x16x32_bf16 v[40:43], v[120:123], a[72:75], v[40:43]
    ds_read_b64_tr_b16 a[148:149], v11 offset:34816
    v_mfma_f32_16x16x32_bf16 v[44:47], v[120:123], a[76:79], v[44:47]
    ds_read_b64_tr_b16 a[150:151], v11 offset:38912
    v_mfma_f32_16x16x32_bf16 v[32:35], v[124:127], a[80:83], v[32:35]
    ds_read_b64_tr_b16 a[152:153], v12 offset:34816
    v_mfma_f32_16x16x32_bf16 v[36:39], v[124:127], a[84:87], v[36:39]
    buffer_load_dwordx4 v[180:183], v4, s[40:43], s74 offen offset:1024 sc1
    ds_read_b64_tr_b16 a[154:155], v12 offset:38912
    v_mfma_f32_16x16x32_bf16 v[40:43], v[124:127], a[88:91], v[40:43]
    ds_read_b64_tr_b16 a[156:157], v13 offset:34816
    v_mfma_f32_16x16x32_bf16 v[44:47], v[124:127], a[92:95], v[44:47]
    ds_read_b64_tr_b16 a[158:159], v13 offset:38912
    s_waitcnt lgkmcnt(15)
    s_waitcnt vmcnt(12)
    v_mfma_f32_16x16x32_bf16 v[16:19], v[128:131], a[96:99], v[16:19]
    ds_read_b64_tr_b16 a[160:161], v10 offset:0
    v_mfma_f32_16x16x32_bf16 v[20:23], v[128:131], a[100:103], v[20:23]
    buffer_load_dwordx4 v[184:187], v4, s[40:43], s74 offen offset:2048 sc1
    ds_read_b64_tr_b16 a[162:163], v10 offset:4096
    v_mfma_f32_16x16x32_bf16 v[24:27], v[128:131], a[104:107], v[24:27]
    ds_read_b64_tr_b16 a[164:165], v11 offset:0
    v_mfma_f32_16x16x32_bf16 v[28:31], v[128:131], a[108:111], v[28:31]
    ds_read_b64_tr_b16 a[166:167], v11 offset:4096
    v_mfma_f32_16x16x32_bf16 v[16:19], v[132:135], a[112:115], v[16:19]
    ds_read_b64_tr_b16 a[168:169], v12 offset:0
    v_mfma_f32_16x16x32_bf16 v[20:23], v[132:135], a[116:119], v[20:23]
    buffer_load_dwordx4 v[188:191], v4, s[40:43], s74 offen offset:3072 sc1
    ds_read_b64_tr_b16 a[170:171], v12 offset:4096
    v_mfma_f32_16x16x32_bf16 v[24:27], v[132:135], a[120:123], v[24:27]
    ds_read_b64_tr_b16 a[172:173], v13 offset:0
    v_mfma_f32_16x16x32_bf16 v[28:31], v[132:135], a[124:127], v[28:31]
    ds_read_b64_tr_b16 a[174:175], v13 offset:4096
    s_waitcnt vmcnt(12)
    v_mfma_f32_16x16x32_bf16 v[32:35], v[136:139], a[96:99], v[32:35]
    ds_read_b64_tr_b16 a[176:177], v10 offset:2048
    v_mfma_f32_16x16x32_bf16 v[36:39], v[136:139], a[100:103], v[36:39]
    buffer_load_dwordx4 v[192:195], v6, s[40:43], s68 offen offset:0 sc1
    ds_read_b64_tr_b16 a[178:179], v10 offset:6144
    v_mfma_f32_16x16x32_bf16 v[40:43], v[136:139], a[104:107], v[40:43]
    ds_read_b64_tr_b16 a[180:181], v11 offset:2048
    v_mfma_f32_16x16x32_bf16 v[44:47], v[136:139], a[108:111], v[44:47]
    ds_read_b64_tr_b16 a[182:183], v11 offset:6144
    v_mfma_f32_16x16x32_bf16 v[32:35], v[140:143], a[112:115], v[32:35]
    ds_read_b64_tr_b16 a[184:185], v12 offset:2048
    v_mfma_f32_16x16x32_bf16 v[36:39], v[140:143], a[116:119], v[36:39]
    buffer_load_dwordx4 v[196:199], v6, s[40:43], s68 offen offset:1024 sc1
    ds_read_b64_tr_b16 a[186:187], v12 offset:6144
    v_mfma_f32_16x16x32_bf16 v[40:43], v[140:143], a[120:123], v[40:43]
    ds_read_b64_tr_b16 a[188:189], v13 offset:2048
    v_mfma_f32_16x16x32_bf16 v[44:47], v[140:143], a[124:127], v[44:47]
    ds_read_b64_tr_b16 a[190:191], v13 offset:6144
    s_waitcnt lgkmcnt(15)
    s_waitcnt vmcnt(12)
    v_mfma_f32_16x16x32_bf16 v[16:19], v[144:147], a[128:131], v[16:19]
    ds_read_b64_tr_b16 a[192:193], v10 offset:8192
    v_mfma_f32_16x16x32_bf16 v[20:23], v[144:147], a[132:135], v[20:23]
    buffer_load_dwordx4 v[200:203], v6, s[40:43], s68 offen offset:2048 sc1
    ds_read_b64_tr_b16 a[194:195], v10 offset:12288
    v_mfma_f32_16x16x32_bf16 v[24:27], v[144:147], a[136:139], v[24:27]
    ds_read_b64_tr_b16 a[196:197], v11 offset:8192
    v_mfma_f32_16x16x32_bf16 v[28:31], v[144:147], a[140:143], v[28:31]
    ds_read_b64_tr_b16 a[198:199], v11 offset:12288
    v_mfma_f32_16x16x32_bf16 v[16:19], v[148:151], a[144:147], v[16:19]
    ds_read_b64_tr_b16 a[200:201], v12 offset:8192
    v_mfma_f32_16x16x32_bf16 v[20:23], v[148:151], a[148:151], v[20:23]
    buffer_load_dwordx4 v[204:207], v6, s[40:43], s68 offen offset:3072 sc1
    ds_read_b64_tr_b16 a[202:203], v12 offset:12288
    v_mfma_f32_16x16x32_bf16 v[24:27], v[148:151], a[152:155], v[24:27]
    ds_read_b64_tr_b16 a[204:205], v13 offset:8192
    v_mfma_f32_16x16x32_bf16 v[28:31], v[148:151], a[156:159], v[28:31]
    ds_read_b64_tr_b16 a[206:207], v13 offset:12288
    s_waitcnt vmcnt(12)
    v_mfma_f32_16x16x32_bf16 v[32:35], v[152:155], a[128:131], v[32:35]
    ds_read_b64_tr_b16 a[208:209], v10 offset:10240
    v_mfma_f32_16x16x32_bf16 v[36:39], v[152:155], a[132:135], v[36:39]
    buffer_load_dwordx4 v[80:83], v6, s[40:43], s69 offen offset:0 sc1
    ds_read_b64_tr_b16 a[210:211], v10 offset:14336
    v_mfma_f32_16x16x32_bf16 v[40:43], v[152:155], a[136:139], v[40:43]
    ds_read_b64_tr_b16 a[212:213], v11 offset:10240
    v_mfma_f32_16x16x32_bf16 v[44:47], v[152:155], a[140:143], v[44:47]
    ds_read_b64_tr_b16 a[214:215], v11 offset:14336
    v_mfma_f32_16x16x32_bf16 v[32:35], v[156:159], a[144:147], v[32:35]
    ds_read_b64_tr_b16 a[216:217], v12 offset:10240
    v_mfma_f32_16x16x32_bf16 v[36:39], v[156:159], a[148:151], v[36:39]
    buffer_load_dwordx4 v[84:87], v6, s[40:43], s69 offen offset:1024 sc1
    ds_read_b64_tr_b16 a[218:219], v12 offset:14336
    v_mfma_f32_16x16x32_bf16 v[40:43], v[156:159], a[152:155], v[40:43]
    ds_read_b64_tr_b16 a[220:221], v13 offset:10240
    v_mfma_f32_16x16x32_bf16 v[44:47], v[156:159], a[156:159], v[44:47]
    ds_read_b64_tr_b16 a[222:223], v13 offset:14336
    s_waitcnt lgkmcnt(15)
    s_waitcnt vmcnt(12)
    v_mfma_f32_16x16x32_bf16 v[16:19], v[160:163], a[160:163], v[16:19]
    v_add_u32 v242, 40960, v4
    v_add_u32 v243, 81920, v4
    v_mfma_f32_16x16x32_bf16 v[20:23], v[160:163], a[164:167], v[20:23]
    buffer_load_dwordx4 v[88:91], v6, s[40:43], s69 offen offset:2048 sc1
    v_add_u32 v10, 122880, v4
    s_cmp_eq_u32 s5, 13
    v_mfma_f32_16x16x32_bf16 v[24:27], v[160:163], a[168:171], v[24:27]
    s_cselect_b32 s52, 6, 13
    s_cselect_b32 s53, 1073741824, 0
    v_mfma_f32_16x16x32_bf16 v[28:31], v[160:163], a[172:175], v[28:31]
    v_add_u32 v240, s53, v4
    v_min_u32 v248, s52, v0
    v_mfma_f32_16x16x32_bf16 v[16:19], v[164:167], a[176:179], v[16:19]
    v_lshlrev_b32 v248, 7, v248
    v_min_u32 v241, 4, v0
    v_mfma_f32_16x16x32_bf16 v[20:23], v[164:167], a[180:183], v[20:23]
    buffer_load_dwordx4 v[92:95], v6, s[40:43], s69 offen offset:3072 sc1
    v_lshlrev_b32 v241, 7, v241
    v_subrev_u32 v1, 14, v0
    v_mfma_f32_16x16x32_bf16 v[24:27], v[164:167], a[184:187], v[24:27]
    v_min_u32 v1, 4, v1
    v_lshlrev_b32 v1, 7, v1
    v_mfma_f32_16x16x32_bf16 v[28:31], v[164:167], a[188:191], v[28:31]
    v_add_u32 v1, s7, v1
    v_add_u32 v249, s8, v248
    s_waitcnt vmcnt(12)
    v_mfma_f32_16x16x32_bf16 v[32:35], v[168:171], a[160:163], v[32:35]
    v_cmp_gt_u32 vcc, 14, v0
    s_mov_b32 s11, 0
    v_mfma_f32_16x16x32_bf16 v[36:39], v[168:171], a[164:167], v[36:39]
    buffer_load_dwordx4 v[96:99], v6, s[40:43], s70 offen offset:0 sc1
    s_nop 0
    v_cndmask_b32 v249, v1, v249, vcc
    v_mfma_f32_16x16x32_bf16 v[40:43], v[168:171], a[168:171], v[40:43]
    v_and_b32 v1, 15, v0
    v_lshrrev_b32 v2, 4, v0
    v_mfma_f32_16x16x32_bf16 v[44:47], v[168:171], a[172:175], v[44:47]
    v_lshlrev_b32 v2, 1, v2
    v_and_b32 v3, 7, v0
    v_mfma_f32_16x16x32_bf16 v[32:35], v[172:175], a[176:179], v[32:35]
    v_xor_b32 v2, v2, v3
    v_lshlrev_b32 v1, 7, v1
    v_mfma_f32_16x16x32_bf16 v[36:39], v[172:175], a[180:183], v[36:39]
    buffer_load_dwordx4 v[100:103], v6, s[40:43], s70 offen offset:1024 sc1
    v_mfma_f32_16x16x32_bf16 v[40:43], v[172:175], a[184:187], v[40:43]
    v_mfma_f32_16x16x32_bf16 v[44:47], v[172:175], a[188:191], v[44:47]
    s_waitcnt lgkmcnt(0)
    s_waitcnt vmcnt(12)
    v_mfma_f32_16x16x32_bf16 v[16:19], v[176:179], a[192:195], v[16:19]
    v_add_u32 v1, s58, v1
    v_mfma_f32_16x16x32_bf16 v[20:23], v[176:179], a[196:199], v[20:23]
    buffer_load_dwordx4 v[104:107], v6, s[40:43], s70 offen offset:2048 sc1
    v_lshl_add_u32 v11, v2, 4, v1
    v_mfma_f32_16x16x32_bf16 v[24:27], v[176:179], a[200:203], v[24:27]
    v_xor_b32 v2, 1, v2
    v_mfma_f32_16x16x32_bf16 v[28:31], v[176:179], a[204:207], v[28:31]
    v_lshl_add_u32 v12, v2, 4, v1
    v_mfma_f32_16x16x32_bf16 v[16:19], v[180:183], a[208:211], v[16:19]
    v_lshrrev_b32 v1, 3, v0
    v_mfma_f32_16x16x32_bf16 v[20:23], v[180:183], a[212:215], v[20:23]
    buffer_load_dwordx4 v[108:111], v6, s[40:43], s70 offen offset:3072 sc1
    v_xor_b32 v2, v1, v3
    v_mfma_f32_16x16x32_bf16 v[24:27], v[180:183], a[216:219], v[24:27]
    v_mul_u32_u24 v1, 3456, v1
    v_mfma_f32_16x16x32_bf16 v[28:31], v[180:183], a[220:223], v[28:31]
    v_lshl_add_u32 v5, v2, 4, v1
    s_waitcnt vmcnt(12)
    v_mfma_f32_16x16x32_bf16 v[32:35], v[184:187], a[192:195], v[32:35]
    v_add_u32 v13, s58, v4
    v_mfma_f32_16x16x32_bf16 v[36:39], v[184:187], a[196:199], v[36:39]
    buffer_load_dwordx4 v[112:115], v6, s[40:43], s71 offen offset:0 sc1
    v_mfma_f32_16x16x32_bf16 v[40:43], v[184:187], a[200:203], v[40:43]
    v_mfma_f32_16x16x32_bf16 v[44:47], v[184:187], a[204:207], v[44:47]
    v_mfma_f32_16x16x32_bf16 v[32:35], v[188:191], a[208:211], v[32:35]
    v_mfma_f32_16x16x32_bf16 v[36:39], v[188:191], a[212:215], v[36:39]
    buffer_load_dwordx4 v[116:119], v6, s[40:43], s71 offen offset:1024 sc1
    v_mfma_f32_16x16x32_bf16 v[40:43], v[188:191], a[216:219], v[40:43]
    v_mfma_f32_16x16x32_bf16 v[44:47], v[188:191], a[220:223], v[44:47]
    s_waitcnt vmcnt(12)
    v_mfma_f32_16x16x32_bf16 v[48:51], v[192:195], a[0:3], 0
    v_mfma_f32_16x16x32_bf16 v[52:55], v[192:195], a[4:7], 0
    buffer_load_dwordx4 v[120:123], v6, s[40:43], s71 offen offset:2048 sc1
    v_mfma_f32_16x16x32_bf16 v[56:59], v[192:195], a[8:11], 0
    v_mfma_f32_16x16x32_bf16 v[60:63], v[192:195], a[12:15], 0
    v_mfma_f32_16x16x32_bf16 v[48:51], v[196:199], a[16:19], v[48:51]
    v_mfma_f32_16x16x32_bf16 v[52:55], v[196:199], a[20:23], v[52:55]
    buffer_load_dwordx4 v[124:127], v6, s[40:43], s71 offen offset:3072 sc1
    v_mfma_f32_16x16x32_bf16 v[56:59], v[196:199], a[24:27], v[56:59]
    v_mfma_f32_16x16x32_bf16 v[60:63], v[196:199], a[28:31], v[60:63]
    s_waitcnt vmcnt(12)
    v_mfma_f32_16x16x32_bf16 v[64:67], v[200:203], a[0:3], 0
    ds_write_b128 v244, v[20:23] offset:0
    v_mfma_f32_16x16x32_bf16 v[68:71], v[200:203], a[4:7], 0
    buffer_load_dwordx4 v[128:131], v6, s[40:43], s72 offen offset:0 sc1
    ds_write_b128 v244, v[24:27] offset:2048
    v_mfma_f32_16x16x32_bf16 v[72:75], v[200:203], a[8:11], 0
    ds_write_b128 v244, v[28:31] offset:4096
    v_mfma_f32_16x16x32_bf16 v[76:79], v[200:203], a[12:15], 0
    ds_write_b128 v244, v[36:39] offset:1024
    v_mfma_f32_16x16x32_bf16 v[64:67], v[204:207], a[16:19], v[64:67]
    ds_write_b128 v244, v[40:43] offset:3072
    v_mfma_f32_16x16x32_bf16 v[68:71], v[204:207], a[20:23], v[68:71]
    buffer_load_dwordx4 v[132:135], v6, s[40:43], s72 offen offset:1024 sc1
    ds_write_b128 v244, v[44:47] offset:5120
    v_mfma_f32_16x16x32_bf16 v[72:75], v[204:207], a[24:27], v[72:75]
    v_mfma_f32_16x16x32_bf16 v[76:79], v[204:207], a[28:31], v[76:79]
    s_waitcnt lgkmcnt(0)
    s_barrier
    s_waitcnt vmcnt(12)
    v_mfma_f32_16x16x32_bf16 v[48:51], v[80:83], a[32:35], v[48:51]
    ds_read_b128 v[20:23], v245 offset:0
    ds_read_b128 v[24:27], v246 offset:2048
    v_mfma_f32_16x16x32_bf16 v[52:55], v[80:83], a[36:39], v[52:55]
    buffer_load_dwordx4 v[136:139], v6, s[40:43], s72 offen offset:2048 sc1
    ds_read_b128 v[28:31], v247 offset:4096
    ds_read_b128 v[36:39], v245 offset:1024
    v_mfma_f32_16x16x32_bf16 v[56:59], v[80:83], a[40:43], v[56:59]
    ds_read_b128 v[40:43], v246 offset:3072
    ds_read_b128 v[44:47], v247 offset:5120
    v_mfma_f32_16x16x32_bf16 v[60:63], v[80:83], a[44:47], v[60:63]
    v_mfma_f32_16x16x32_bf16 v[48:51], v[84:87], a[48:51], v[48:51]
    v_mfma_f32_16x16x32_bf16 v[52:55], v[84:87], a[52:55], v[52:55]
    buffer_load_dwordx4 v[140:143], v6, s[40:43], s72 offen offset:3072 sc1
    v_mfma_f32_16x16x32_bf16 v[56:59], v[84:87], a[56:59], v[56:59]
    v_mfma_f32_16x16x32_bf16 v[60:63], v[84:87], a[60:63], v[60:63]
    s_waitcnt vmcnt(12)
    v_mfma_f32_16x16x32_bf16 v[64:67], v[88:91], a[32:35], v[64:67]
    s_waitcnt lgkmcnt(0)
    v_add_f32 v16, v16, v20
    v_mfma_f32_16x16x32_bf16 v[68:71], v[88:91], a[36:39], v[68:71]
    buffer_load_dwordx4 v[144:147], v6, s[40:43], s73 offen offset:0 sc1
    v_add_f32 v24, v24, v28
    v_add_f32 v17, v17, v21
    v_mfma_f32_16x16x32_bf16 v[72:75], v[88:91], a[40:43], v[72:75]
    v_add_f32 v25, v25, v29
    v_add_f32 v18, v18, v22
    v_mfma_f32_16x16x32_bf16 v[76:79], v[88:91], a[44:47], v[76:79]
    v_add_f32 v26, v26, v30
    v_add_f32 v19, v19, v23
    v_mfma_f32_16x16x32_bf16 v[64:67], v[92:95], a[48:51], v[64:67]
    v_add_f32 v27, v27, v31
    v_add_f32 v16, v16, v24
    v_mfma_f32_16x16x32_bf16 v[68:71], v[92:95], a[52:55], v[68:71]
    buffer_load_dwordx4 v[148:151], v6, s[40:43], s73 offen offset:1024 sc1
    v_add_f32 v17, v17, v25
    v_add_f32 v18, v18, v26
    v_mfma_f32_16x16x32_bf16 v[72:75], v[92:95], a[56:59], v[72:75]
    v_add_f32 v19, v19, v27
    v_add_f32 v32, v32, v36
    v_mfma_f32_16x16x32_bf16 v[76:79], v[92:95], a[60:63], v[76:79]
    v_add_f32 v40, v40, v44
    v_add_f32 v33, v33, v37
    s_waitcnt vmcnt(12)
    v_mfma_f32_16x16x32_bf16 v[48:51], v[96:99], a[64:67], v[48:51]
    v_add_f32 v41, v41, v45
    v_add_f32 v34, v34, v38
    v_mfma_f32_16x16x32_bf16 v[52:55], v[96:99], a[68:71], v[52:55]
    buffer_load_dwordx4 v[152:155], v6, s[40:43], s73 offen offset:2048 sc1
    v_add_f32 v42, v42, v46
    v_add_f32 v35, v35, v39
    v_mfma_f32_16x16x32_bf16 v[56:59], v[96:99], a[72:75], v[56:59]
    v_add_f32 v43, v43, v47
    v_add_f32 v32, v32, v40
    v_mfma_f32_16x16x32_bf16 v[60:63], v[96:99], a[76:79], v[60:63]
    v_add_f32 v33, v33, v41
    v_add_f32 v34, v34, v42
    v_mfma_f32_16x16x32_bf16 v[48:51], v[100:103], a[80:83], v[48:51]
    v_add_f32 v35, v35, v43
    v_cvt_pk_bf16_f32 v20, v16, v17
    v_mfma_f32_16x16x32_bf16 v[52:55], v[100:103], a[84:87], v[52:55]
    buffer_load_dwordx4 v[156:159], v6, s[40:43], s73 offen offset:3072 sc1
    v_cvt_pk_bf16_f32 v21, v18, v19
    v_cvt_pk_bf16_f32 v22, v32, v33
    v_mfma_f32_16x16x32_bf16 v[56:59], v[100:103], a[88:91], v[56:59]
    v_cvt_pk_bf16_f32 v23, v34, v35
    buffer_store_dwordx4 v[20:23], v4, s[24:27], s76 offen sc0 sc1
    v_mfma_f32_16x16x32_bf16 v[60:63], v[100:103], a[92:95], v[60:63]
    s_waitcnt vmcnt(13)
    v_mfma_f32_16x16x32_bf16 v[64:67], v[104:107], a[64:67], v[64:67]
    v_mfma_f32_16x16x32_bf16 v[68:71], v[104:107], a[68:71], v[68:71]
    buffer_load_dwordx4 v[160:163], v6, s[40:43], s74 offen offset:0 sc1
    v_mfma_f32_16x16x32_bf16 v[72:75], v[104:107], a[72:75], v[72:75]
    v_mfma_f32_16x16x32_bf16 v[76:79], v[104:107], a[76:79], v[76:79]
    v_mfma_f32_16x16x32_bf16 v[64:67], v[108:111], a[80:83], v[64:67]
    v_mfma_f32_16x16x32_bf16 v[68:71], v[108:111], a[84:87], v[68:71]
    buffer_load_dwordx4 v[164:167], v6, s[40:43], s74 offen offset:1024 sc1
    v_mfma_f32_16x16x32_bf16 v[72:75], v[108:111], a[88:91], v[72:75]
    v_mfma_f32_16x16x32_bf16 v[76:79], v[108:111], a[92:95], v[76:79]
    s_waitcnt vmcnt(13)
    v_mfma_f32_16x16x32_bf16 v[48:51], v[112:115], a[96:99], v[48:51]
    s_mov_b32 s32, s16
    s_mov_b32 s33, s17
    v_mfma_f32_16x16x32_bf16 v[52:55], v[112:115], a[100:103], v[52:55]
    buffer_load_dwordx4 v[168:171], v6, s[40:43], s74 offen offset:2048 sc1
    s_mov_b32 s34, 7077888
    s_mov_b32 s35, 0x20000
    v_mfma_f32_16x16x32_bf16 v[56:59], v[112:115], a[104:107], v[56:59]
    s_lshl_b32 s52, s4, 7
    s_lshl_b32 s53, s3, 5
    v_mfma_f32_16x16x32_bf16 v[60:63], v[112:115], a[108:111], v[60:63]
    s_add_u32 s52, s52, s53
    s_mul_i32 s52, s52, 3456
    v_mfma_f32_16x16x32_bf16 v[48:51], v[116:119], a[112:115], v[48:51]
    s_lshl_b32 s53, s5, 8
    s_add_u32 s60, s52, s53
    v_mfma_f32_16x16x32_bf16 v[52:55], v[116:119], a[116:119], v[52:55]
    buffer_load_dwordx4 v[172:175], v6, s[40:43], s74 offen offset:3072 sc1
    s_add_u32 s61, s60, 27648
    s_add_u32 s62, s60, 55296
    v_mfma_f32_16x16x32_bf16 v[56:59], v[116:119], a[120:123], v[56:59]
    s_add_u32 s63, s60, 82944
    s_add_u32 s64, s60, 128
    v_mfma_f32_16x16x32_bf16 v[60:63], v[116:119], a[124:127], v[60:63]
    s_cmp_eq_u32 s5, 13
    s_cselect_b32 s64, 1073741824, s64
    s_waitcnt vmcnt(13)
    v_mfma_f32_16x16x32_bf16 v[64:67], v[120:123], a[96:99], v[64:67]
    s_add_u32 s65, s64, 27648
    s_add_u32 s66, s64, 55296
    v_mfma_f32_16x16x32_bf16 v[68:71], v[120:123], a[100:103], v[68:71]
    buffer_load_dwordx4 v[176:179], v7, s[40:43], s68 offen offset:0 sc1
    s_add_u32 s67, s64, 82944
    v_mfma_f32_16x16x32_bf16 v[72:75], v[120:123], a[104:107], v[72:75]
    v_mfma_f32_16x16x32_bf16 v[76:79], v[120:123], a[108:111], v[76:79]
    v_mfma_f32_16x16x32_bf16 v[64:67], v[124:127], a[112:115], v[64:67]
    v_mfma_f32_16x16x32_bf16 v[68:71], v[124:127], a[116:119], v[68:71]
    buffer_load_dwordx4 v[180:183], v7, s[40:43], s68 offen offset:1024 sc1
    v_mfma_f32_16x16x32_bf16 v[72:75], v[124:127], a[120:123], v[72:75]
    v_mfma_f32_16x16x32_bf16 v[76:79], v[124:127], a[124:127], v[76:79]
    s_waitcnt vmcnt(13)
    v_mfma_f32_16x16x32_bf16 v[48:51], v[128:131], a[128:131], v[48:51]
    v_mfma_f32_16x16x32_bf16 v[52:55], v[128:131], a[132:135], v[52:55]
    buffer_load_dwordx4 v[184:187], v7, s[40:43], s68 offen offset:2048 sc1
    v_mfma_f32_16x16x32_bf16 v[56:59], v[128:131], a[136:139], v[56:59]
    v_mfma_f32_16x16x32_bf16 v[60:63], v[128:131], a[140:143], v[60:63]
    v_mfma_f32_16x16x32_bf16 v[48:51], v[132:135], a[144:147], v[48:51]
    v_mfma_f32_16x16x32_bf16 v[52:55], v[132:135], a[148:151], v[52:55]
    buffer_load_dwordx4 v[188:191], v7, s[40:43], s68 offen offset:3072 sc1
    v_mfma_f32_16x16x32_bf16 v[56:59], v[132:135], a[152:155], v[56:59]
    v_mfma_f32_16x16x32_bf16 v[60:63], v[132:135], a[156:159], v[60:63]
    s_waitcnt vmcnt(13)
    v_mfma_f32_16x16x32_bf16 v[64:67], v[136:139], a[128:131], v[64:67]
    v_mfma_f32_16x16x32_bf16 v[68:71], v[136:139], a[132:135], v[68:71]
    buffer_load_dwordx4 v[192:195], v7, s[40:43], s69 offen offset:0 sc1
    v_mfma_f32_16x16x32_bf16 v[72:75], v[136:139], a[136:139], v[72:75]
    v_mfma_f32_16x16x32_bf16 v[76:79], v[136:139], a[140:143], v[76:79]
    v_mfma_f32_16x16x32_bf16 v[64:67], v[140:143], a[144:147], v[64:67]
    v_mfma_f32_16x16x32_bf16 v[68:71], v[140:143], a[148:151], v[68:71]
    buffer_load_dwordx4 v[196:199], v7, s[40:43], s69 offen offset:1024 sc1
    v_mfma_f32_16x16x32_bf16 v[72:75], v[140:143], a[152:155], v[72:75]
    v_mfma_f32_16x16x32_bf16 v[76:79], v[140:143], a[156:159], v[76:79]
    s_waitcnt vmcnt(10)
    buffer_store_dword v14, v15, s[44:47], s78 offen offset:0 sc0 sc1
    v_mfma_f32_16x16x32_bf16 v[48:51], v[144:147], a[160:163], v[48:51]
    v_mfma_f32_16x16x32_bf16 v[52:55], v[144:147], a[164:167], v[52:55]
    buffer_load_dwordx4 v[200:203], v7, s[40:43], s69 offen offset:2048 sc1
    v_mfma_f32_16x16x32_bf16 v[56:59], v[144:147], a[168:171], v[56:59]
    v_mfma_f32_16x16x32_bf16 v[60:63], v[144:147], a[172:175], v[60:63]
    v_mfma_f32_16x16x32_bf16 v[48:51], v[148:151], a[176:179], v[48:51]
    v_mfma_f32_16x16x32_bf16 v[52:55], v[148:151], a[180:183], v[52:55]
    buffer_load_dwordx4 v[204:207], v7, s[40:43], s69 offen offset:3072 sc1
    v_mfma_f32_16x16x32_bf16 v[56:59], v[148:151], a[184:187], v[56:59]
    v_mfma_f32_16x16x32_bf16 v[60:63], v[148:151], a[188:191], v[60:63]
    s_waitcnt vmcnt(14)
    v_mfma_f32_16x16x32_bf16 v[64:67], v[152:155], a[160:163], v[64:67]
    v_mfma_f32_16x16x32_bf16 v[68:71], v[152:155], a[164:167], v[68:71]
    buffer_load_dwordx4 v[80:83], v7, s[40:43], s70 offen offset:0 sc1
    v_mfma_f32_16x16x32_bf16 v[72:75], v[152:155], a[168:171], v[72:75]
    v_mfma_f32_16x16x32_bf16 v[76:79], v[152:155], a[172:175], v[76:79]
    v_mfma_f32_16x16x32_bf16 v[64:67], v[156:159], a[176:179], v[64:67]
    v_mfma_f32_16x16x32_bf16 v[68:71], v[156:159], a[180:183], v[68:71]
    buffer_load_dwordx4 v[84:87], v7, s[40:43], s70 offen offset:1024 sc1
    v_mfma_f32_16x16x32_bf16 v[72:75], v[156:159], a[184:187], v[72:75]
    v_mfma_f32_16x16x32_bf16 v[76:79], v[156:159], a[188:191], v[76:79]
    s_waitcnt vmcnt(13)
    v_mfma_f32_16x16x32_bf16 v[48:51], v[160:163], a[192:195], v[48:51]
    v_mfma_f32_16x16x32_bf16 v[52:55], v[160:163], a[196:199], v[52:55]
    buffer_load_dwordx4 v[88:91], v7, s[40:43], s70 offen offset:2048 sc1
    v_mfma_f32_16x16x32_bf16 v[56:59], v[160:163], a[200:203], v[56:59]
    v_mfma_f32_16x16x32_bf16 v[60:63], v[160:163], a[204:207], v[60:63]
    v_mfma_f32_16x16x32_bf16 v[48:51], v[164:167], a[208:211], v[48:51]
    v_mfma_f32_16x16x32_bf16 v[52:55], v[164:167], a[212:215], v[52:55]
    buffer_load_dwordx4 v[92:95], v7, s[40:43], s70 offen offset:3072 sc1
    v_mfma_f32_16x16x32_bf16 v[56:59], v[164:167], a[216:219], v[56:59]
    v_mfma_f32_16x16x32_bf16 v[60:63], v[164:167], a[220:223], v[60:63]
    s_waitcnt vmcnt(13)
    v_mfma_f32_16x16x32_bf16 v[64:67], v[168:171], a[192:195], v[64:67]
    v_mfma_f32_16x16x32_bf16 v[68:71], v[168:171], a[196:199], v[68:71]
    buffer_load_dwordx4 v[96:99], v7, s[40:43], s71 offen offset:0 sc1
    v_mfma_f32_16x16x32_bf16 v[72:75], v[168:171], a[200:203], v[72:75]
    v_mfma_f32_16x16x32_bf16 v[76:79], v[168:171], a[204:207], v[76:79]
    v_mfma_f32_16x16x32_bf16 v[64:67], v[172:175], a[208:211], v[64:67]
    v_mfma_f32_16x16x32_bf16 v[68:71], v[172:175], a[212:215], v[68:71]
    buffer_load_dwordx4 v[100:103], v7, s[40:43], s71 offen offset:1024 sc1
    v_mfma_f32_16x16x32_bf16 v[72:75], v[172:175], a[216:219], v[72:75]
    v_mfma_f32_16x16x32_bf16 v[76:79], v[172:175], a[220:223], v[76:79]
    s_waitcnt vmcnt(13)
    v_mfma_f32_16x16x32_bf16 v[16:19], v[176:179], a[0:3], 0
    v_mfma_f32_16x16x32_bf16 v[20:23], v[176:179], a[4:7], 0
    buffer_load_dwordx4 v[104:107], v7, s[40:43], s71 offen offset:2048 sc1
    v_mfma_f32_16x16x32_bf16 v[24:27], v[176:179], a[8:11], 0
    v_mfma_f32_16x16x32_bf16 v[28:31], v[176:179], a[12:15], 0
    v_mfma_f32_16x16x32_bf16 v[16:19], v[180:183], a[16:19], v[16:19]
    v_mfma_f32_16x16x32_bf16 v[20:23], v[180:183], a[20:23], v[20:23]
    buffer_load_dwordx4 v[108:111], v7, s[40:43], s71 offen offset:3072 sc1
    v_mfma_f32_16x16x32_bf16 v[24:27], v[180:183], a[24:27], v[24:27]
    v_mfma_f32_16x16x32_bf16 v[28:31], v[180:183], a[28:31], v[28:31]
    s_waitcnt vmcnt(13)
    v_mfma_f32_16x16x32_bf16 v[32:35], v[184:187], a[0:3], 0
    ds_write_b128 v244, v[52:55] offset:6144
    v_mfma_f32_16x16x32_bf16 v[36:39], v[184:187], a[4:7], 0
    buffer_load_dwordx4 v[112:115], v7, s[40:43], s72 offen offset:0 sc1
    ds_write_b128 v244, v[56:59] offset:8192
    v_mfma_f32_16x16x32_bf16 v[40:43], v[184:187], a[8:11], 0
    ds_write_b128 v244, v[60:63] offset:10240
    v_mfma_f32_16x16x32_bf16 v[44:47], v[184:187], a[12:15], 0
    ds_write_b128 v244, v[68:71] offset:7168
    v_mfma_f32_16x16x32_bf16 v[32:35], v[188:191], a[16:19], v[32:35]
    ds_write_b128 v244, v[72:75] offset:9216
    v_mfma_f32_16x16x32_bf16 v[36:39], v[188:191], a[20:23], v[36:39]
    buffer_load_dwordx4 v[116:119], v7, s[40:43], s72 offen offset:1024 sc1
    ds_write_b128 v244, v[76:79] offset:11264
    v_mfma_f32_16x16x32_bf16 v[40:43], v[188:191], a[24:27], v[40:43]
    v_mfma_f32_16x16x32_bf16 v[44:47], v[188:191], a[28:31], v[44:47]
    s_waitcnt lgkmcnt(0)
    s_barrier
    s_waitcnt vmcnt(13)
    v_mfma_f32_16x16x32_bf16 v[16:19], v[192:195], a[32:35], v[16:19]
    ds_read_b128 v[52:55], v245 offset:6144
    ds_read_b128 v[56:59], v246 offset:8192
    v_mfma_f32_16x16x32_bf16 v[20:23], v[192:195], a[36:39], v[20:23]
    buffer_load_dwordx4 v[120:123], v7, s[40:43], s72 offen offset:2048 sc1
    ds_read_b128 v[60:63], v247 offset:10240
    ds_read_b128 v[68:71], v245 offset:7168
    v_mfma_f32_16x16x32_bf16 v[24:27], v[192:195], a[40:43], v[24:27]
    ds_read_b128 v[72:75], v246 offset:9216
    ds_read_b128 v[76:79], v247 offset:11264
    v_mfma_f32_16x16x32_bf16 v[28:31], v[192:195], a[44:47], v[28:31]
    v_mfma_f32_16x16x32_bf16 v[16:19], v[196:199], a[48:51], v[16:19]
    v_mfma_f32_16x16x32_bf16 v[20:23], v[196:199], a[52:55], v[20:23]
    buffer_load_dwordx4 v[124:127], v7, s[40:43], s72 offen offset:3072 sc1
    v_mfma_f32_16x16x32_bf16 v[24:27], v[196:199], a[56:59], v[24:27]
    v_mfma_f32_16x16x32_bf16 v[28:31], v[196:199], a[60:63], v[28:31]
    s_waitcnt vmcnt(12)
    v_mfma_f32_16x16x32_bf16 v[32:35], v[200:203], a[32:35], v[32:35]
    s_waitcnt lgkmcnt(0)
    v_add_f32 v48, v48, v52
    v_mfma_f32_16x16x32_bf16 v[36:39], v[200:203], a[36:39], v[36:39]
    buffer_load_dwordx4 v[128:131], v7, s[40:43], s73 offen offset:0 sc1
    v_add_f32 v56, v56, v60
    v_add_f32 v49, v49, v53
    v_mfma_f32_16x16x32_bf16 v[40:43], v[200:203], a[40:43], v[40:43]
    v_add_f32 v57, v57, v61
    v_add_f32 v50, v50, v54
    v_mfma_f32_16x16x32_bf16 v[44:47], v[200:203], a[44:47], v[44:47]
    v_add_f32 v58, v58, v62
    v_add_f32 v51, v51, v55
    v_mfma_f32_16x16x32_bf16 v[32:35], v[204:207], a[48:51], v[32:35]
    v_add_f32 v59, v59, v63
    v_add_f32 v48, v48, v56
    v_mfma_f32_16x16x32_bf16 v[36:39], v[204:207], a[52:55], v[36:39]
    buffer_load_dwordx4 v[132:135], v7, s[40:43], s73 offen offset:1024 sc1
    v_add_f32 v49, v49, v57
    v_add_f32 v50, v50, v58
    v_mfma_f32_16x16x32_bf16 v[40:43], v[204:207], a[56:59], v[40:43]
    v_add_f32 v51, v51, v59
    v_add_f32 v64, v64, v68
    v_mfma_f32_16x16x32_bf16 v[44:47], v[204:207], a[60:63], v[44:47]
    v_add_f32 v72, v72, v76
    v_add_f32 v65, v65, v69
    s_waitcnt vmcnt(12)
    v_mfma_f32_16x16x32_bf16 v[16:19], v[80:83], a[64:67], v[16:19]
    v_add_f32 v73, v73, v77
    v_add_f32 v66, v66, v70
    v_mfma_f32_16x16x32_bf16 v[20:23], v[80:83], a[68:71], v[20:23]
    buffer_load_dwordx4 v[136:139], v7, s[40:43], s73 offen offset:2048 sc1
    v_add_f32 v74, v74, v78
    v_add_f32 v67, v67, v71
    v_mfma_f32_16x16x32_bf16 v[24:27], v[80:83], a[72:75], v[24:27]
    v_add_f32 v75, v75, v79
    v_add_f32 v64, v64, v72
    v_mfma_f32_16x16x32_bf16 v[28:31], v[80:83], a[76:79], v[28:31]
    v_add_f32 v65, v65, v73
    v_add_f32 v66, v66, v74
    v_mfma_f32_16x16x32_bf16 v[16:19], v[84:87], a[80:83], v[16:19]
    v_add_f32 v67, v67, v75
    v_cvt_pk_bf16_f32 v52, v48, v49
    v_mfma_f32_16x16x32_bf16 v[20:23], v[84:87], a[84:87], v[20:23]
    buffer_load_dwordx4 v[140:143], v7, s[40:43], s73 offen offset:3072 sc1
    v_cvt_pk_bf16_f32 v53, v50, v51
    v_cvt_pk_bf16_f32 v54, v64, v65
    v_mfma_f32_16x16x32_bf16 v[24:27], v[84:87], a[88:91], v[24:27]
    v_cvt_pk_bf16_f32 v55, v66, v67
    buffer_store_dwordx4 v[52:55], v4, s[24:27], s81 offen sc0 sc1
    v_mfma_f32_16x16x32_bf16 v[28:31], v[84:87], a[92:95], v[28:31]
    s_waitcnt vmcnt(13)
    v_mfma_f32_16x16x32_bf16 v[32:35], v[88:91], a[64:67], v[32:35]
    v_mfma_f32_16x16x32_bf16 v[36:39], v[88:91], a[68:71], v[36:39]
    buffer_load_dwordx4 v[144:147], v7, s[40:43], s74 offen offset:0 sc1
    v_mfma_f32_16x16x32_bf16 v[40:43], v[88:91], a[72:75], v[40:43]
    v_mfma_f32_16x16x32_bf16 v[44:47], v[88:91], a[76:79], v[44:47]
    v_mfma_f32_16x16x32_bf16 v[32:35], v[92:95], a[80:83], v[32:35]
    v_mfma_f32_16x16x32_bf16 v[36:39], v[92:95], a[84:87], v[36:39]
    buffer_load_dwordx4 v[148:151], v7, s[40:43], s74 offen offset:1024 sc1
    v_mfma_f32_16x16x32_bf16 v[40:43], v[92:95], a[88:91], v[40:43]
    v_mfma_f32_16x16x32_bf16 v[44:47], v[92:95], a[92:95], v[44:47]
    buffer_load_dword v8, v249, s[44:47], s11 offen offset:0 sc0 sc1
    s_waitcnt vmcnt(14)
    v_mfma_f32_16x16x32_bf16 v[16:19], v[96:99], a[96:99], v[16:19]
    v_mfma_f32_16x16x32_bf16 v[20:23], v[96:99], a[100:103], v[20:23]
    buffer_load_dwordx4 v[152:155], v7, s[40:43], s74 offen offset:2048 sc1
    v_mfma_f32_16x16x32_bf16 v[24:27], v[96:99], a[104:107], v[24:27]
    v_mfma_f32_16x16x32_bf16 v[28:31], v[96:99], a[108:111], v[28:31]
    v_mfma_f32_16x16x32_bf16 v[16:19], v[100:103], a[112:115], v[16:19]
    v_mfma_f32_16x16x32_bf16 v[20:23], v[100:103], a[116:119], v[20:23]
    buffer_load_dwordx4 v[156:159], v7, s[40:43], s74 offen offset:3072 sc1
    v_mfma_f32_16x16x32_bf16 v[24:27], v[100:103], a[120:123], v[24:27]
    v_mfma_f32_16x16x32_bf16 v[28:31], v[100:103], a[124:127], v[28:31]
    s_waitcnt vmcnt(14)
    v_mfma_f32_16x16x32_bf16 v[32:35], v[104:107], a[96:99], v[32:35]
    v_mfma_f32_16x16x32_bf16 v[36:39], v[104:107], a[100:103], v[36:39]
    v_mfma_f32_16x16x32_bf16 v[40:43], v[104:107], a[104:107], v[40:43]
    v_mfma_f32_16x16x32_bf16 v[44:47], v[104:107], a[108:111], v[44:47]
    v_mfma_f32_16x16x32_bf16 v[32:35], v[108:111], a[112:115], v[32:35]
    v_mfma_f32_16x16x32_bf16 v[36:39], v[108:111], a[116:119], v[36:39]
    v_mfma_f32_16x16x32_bf16 v[40:43], v[108:111], a[120:123], v[40:43]
    v_mfma_f32_16x16x32_bf16 v[44:47], v[108:111], a[124:127], v[44:47]
    s_waitcnt vmcnt(12)
    v_mfma_f32_16x16x32_bf16 v[16:19], v[112:115], a[128:131], v[16:19]
    v_mfma_f32_16x16x32_bf16 v[20:23], v[112:115], a[132:135], v[20:23]
    v_mfma_f32_16x16x32_bf16 v[24:27], v[112:115], a[136:139], v[24:27]
    v_mfma_f32_16x16x32_bf16 v[28:31], v[112:115], a[140:143], v[28:31]
    v_mfma_f32_16x16x32_bf16 v[16:19], v[116:119], a[144:147], v[16:19]
    v_mfma_f32_16x16x32_bf16 v[20:23], v[116:119], a[148:151], v[20:23]
    v_mfma_f32_16x16x32_bf16 v[24:27], v[116:119], a[152:155], v[24:27]
    v_mfma_f32_16x16x32_bf16 v[28:31], v[116:119], a[156:159], v[28:31]
    s_waitcnt vmcnt(10)
    v_mfma_f32_16x16x32_bf16 v[32:35], v[120:123], a[128:131], v[32:35]
    v_mfma_f32_16x16x32_bf16 v[36:39], v[120:123], a[132:135], v[36:39]
    v_mfma_f32_16x16x32_bf16 v[40:43], v[120:123], a[136:139], v[40:43]
    v_mfma_f32_16x16x32_bf16 v[44:47], v[120:123], a[140:143], v[44:47]
    v_mfma_f32_16x16x32_bf16 v[32:35], v[124:127], a[144:147], v[32:35]
    v_mfma_f32_16x16x32_bf16 v[36:39], v[124:127], a[148:151], v[36:39]
    v_mfma_f32_16x16x32_bf16 v[40:43], v[124:127], a[152:155], v[40:43]
    v_mfma_f32_16x16x32_bf16 v[44:47], v[124:127], a[156:159], v[44:47]
    s_waitcnt vmcnt(5)
    buffer_store_dword v14, v15, s[44:47], s79 offen offset:0 sc0 sc1
    v_mfma_f32_16x16x32_bf16 v[16:19], v[128:131], a[160:163], v[16:19]
    v_mfma_f32_16x16x32_bf16 v[20:23], v[128:131], a[164:167], v[20:23]
    v_mfma_f32_16x16x32_bf16 v[24:27], v[128:131], a[168:171], v[24:27]
    v_mfma_f32_16x16x32_bf16 v[28:31], v[128:131], a[172:175], v[28:31]
    v_mfma_f32_16x16x32_bf16 v[16:19], v[132:135], a[176:179], v[16:19]
    v_mfma_f32_16x16x32_bf16 v[20:23], v[132:135], a[180:183], v[20:23]
    v_mfma_f32_16x16x32_bf16 v[24:27], v[132:135], a[184:187], v[24:27]
    v_mfma_f32_16x16x32_bf16 v[28:31], v[132:135], a[188:191], v[28:31]
    s_waitcnt vmcnt(7)
    s_cmp_ge_u32 s23, 28
    s_cbranch_scc1 Lsk_15
    s_waitcnt vmcnt(3)
    v_cmp_ne_u32 vcc, s87, v8
    s_mov_b32 s86, 0
    s_nop 3
    s_cbranch_vccz Lp_17
Lp_16:
    buffer_load_dword v8, v249, s[44:47], s11 offen offset:0 sc0 sc1
    s_add_u32 s86, s86, 1
    s_cmp_gt_u32 s86, 524288
    s_cbranch_scc1 Lend_1
    s_waitcnt vmcnt(0)
    v_cmp_ne_u32 vcc, s87, v8
    s_nop 4
    s_cbranch_vccnz Lp_16
Lp_17:
Lsk_15:
    v_mfma_f32_16x16x32_bf16 v[32:35], v[136:139], a[160:163], v[32:35]
    v_mfma_f32_16x16x32_bf16 v[36:39], v[136:139], a[164:167], v[36:39]
    s_add_u32 m0, s58, 0
    s_mov_b32 s85, 0
    buffer_load_dwordx4 v4, s[12:15], s85 offen offset:0 sc1 lds
    v_mfma_f32_16x16x32_bf16 v[40:43], v[136:139], a[168:171], v[40:43]
    v_mfma_f32_16x16x32_bf16 v[44:47], v[136:139], a[172:175], v[44:47]
    v_mfma_f32_16x16x32_bf16 v[32:35], v[140:143], a[176:179], v[32:35]
    v_mfma_f32_16x16x32_bf16 v[36:39], v[140:143], a[180:183], v[36:39]
    buffer_load_dwordx4 v240, s[12:15], s85 offen offset:1024 sc1 lds
    v_mfma_f32_16x16x32_bf16 v[40:43], v[140:143], a[184:187], v[40:43]
    v_mfma_f32_16x16x32_bf16 v[44:47], v[140:143], a[188:191], v[44:47]
    s_waitcnt vmcnt(6)
    v_mfma_f32_16x16x32_bf16 v[16:19], v[144:147], a[192:195], v[16:19]
    v_mfma_f32_16x16x32_bf16 v[20:23], v[144:147], a[196:199], v[20:23]
    s_mov_b32 s84, 0
    buffer_load_dwordx4 v[160:163], v4, s[92:95], s84 offen offset:0 sc1
    v_mfma_f32_16x16x32_bf16 v[24:27], v[144:147], a[200:203], v[24:27]
    v_mfma_f32_16x16x32_bf16 v[28:31], v[144:147], a[204:207], v[28:31]
    v_mfma_f32_16x16x32_bf16 v[16:19], v[148:151], a[208:211], v[16:19]
    v_mfma_f32_16x16x32_bf16 v[20:23], v[148:151], a[212:215], v[20:23]
    buffer_load_dwordx4 v[164:167], v4, s[92:95], s84 offen offset:1024 sc1
    v_mfma_f32_16x16x32_bf16 v[24:27], v[148:151], a[216:219], v[24:27]
    v_mfma_f32_16x16x32_bf16 v[28:31], v[148:151], a[220:223], v[28:31]
    s_waitcnt vmcnt(5)
    v_mfma_f32_16x16x32_bf16 v[32:35], v[152:155], a[192:195], v[32:35]
    v_mfma_f32_16x16x32_bf16 v[36:39], v[152:155], a[196:199], v[36:39]
    buffer_load_dwordx4 v4, s[12:15], s85 offen offset:2048 sc1 lds
    v_mfma_f32_16x16x32_bf16 v[40:43], v[152:155], a[200:203], v[40:43]
    v_mfma_f32_16x16x32_bf16 v[44:47], v[152:155], a[204:207], v[44:47]
    v_mfma_f32_16x16x32_bf16 v[32:35], v[156:159], a[208:211], v[32:35]
    v_mfma_f32_16x16x32_bf16 v[36:39], v[156:159], a[212:215], v[36:39]
    buffer_load_dwordx4 v240, s[12:15], s85 offen offset:3072 sc1 lds
    v_mfma_f32_16x16x32_bf16 v[40:43], v[156:159], a[216:219], v[40:43]
    v_mfma_f32_16x16x32_bf16 v[44:47], v[156:159], a[220:223], v[44:47]
    ds_write_b128 v244, v[20:23] offset:0
    buffer_load_dwordx4 v[168:171], v4, s[92:95], s84 offen offset:2048 sc1
    ds_write_b128 v244, v[24:27] offset:2048
    buffer_load_dwordx4 v[172:175], v4, s[92:95], s84 offen offset:3072 sc1
    ds_write_b128 v244, v[28:31] offset:4096
    s_add_u32 m0, s58, 4096
    s_mov_b32 s85, 4096
    buffer_load_dwordx4 v4, s[12:15], s85 offen offset:0 sc1 lds
    s_nop 3
    ds_write_b128 v244, v[36:39] offset:1024
    buffer_load_dwordx4 v240, s[12:15], s85 offen offset:1024 sc1 lds
    ds_write_b128 v244, v[40:43] offset:3072
    s_mov_b32 s84, 4096
    buffer_load_dwordx4 v[176:179], v4, s[92:95], s84 offen offset:0 sc1
    ds_write_b128 v244, v[44:47] offset:5120
    buffer_load_dwordx4 v[180:183], v4, s[92:95], s84 offen offset:1024 sc1
    s_waitcnt lgkmcnt(0)
    s_barrier
    ds_read_b128 v[20:23], v245 offset:0
    ds_read_b128 v[24:27], v246 offset:2048
    ds_read_b128 v[28:31], v247 offset:4096
    ds_read_b128 v[36:39], v245 offset:1024
    ds_read_b128 v[40:43], v246 offset:3072
    ds_read_b128 v[44:47], v247 offset:5120
    buffer_load_dwordx4 v4, s[12:15], s85 offen offset:2048 sc1 lds
    buffer_load_dwordx4 v240, s[12:15], s85 offen offset:3072 sc1 lds
    s_waitcnt lgkmcnt(0)
    v_add_f32 v16, v16, v20
    v_add_f32 v24, v24, v28
    v_add_f32 v17, v17, v21
    v_add_f32 v25, v25, v29
    v_add_f32 v18, v18, v22
    buffer_load_dwordx4 v[184:187], v4, s[92:95], s84 offen offset:2048 sc1
    v_add_f32 v26, v26, v30
    v_add_f32 v19, v19, v23
    v_add_f32 v27, v27, v31
    v_add_f32 v16, v16, v24
    v_add_f32 v17, v17, v25
    buffer_load_dwordx4 v[188:191], v4, s[92:95], s84 offen offset:3072 sc1
    v_add_f32 v18, v18, v26
    v_add_f32 v19, v19, v27
    v_add_f32 v32, v32, v36
    v_add_f32 v40, v40, v44
    v_add_f32 v33, v33, v37
    s_add_u32 m0, s58, 8192
    s_mov_b32 s85, 8192
    buffer_load_dwordx4 v4, s[12:15], s85 offen offset:0 sc1 lds
    v_add_f32 v41, v41, v45
    v_add_f32 v34, v34, v38
    v_add_f32 v42, v42, v46
    v_add_f32 v35, v35, v39
    v_add_f32 v43, v43, v47
    buffer_load_dwordx4 v240, s[12:15], s85 offen offset:1024 sc1 lds
    v_add_f32 v32, v32, v40
    v_add_f32 v33, v33, v41
    v_add_f32 v34, v34, v42
    v_add_f32 v35, v35, v43
    v_cvt_pk_bf16_f32 v20, v16, v17
    s_mov_b32 s84, 8192
    buffer_load_dwordx4 v[192:195], v4, s[92:95], s84 offen offset:0 sc1
    v_cvt_pk_bf16_f32 v21, v18, v19
    v_cvt_pk_bf16_f32 v22, v32, v33
    v_cvt_pk_bf16_f32 v23, v34, v35
    buffer_store_dwordx4 v[20:23], v4, s[24:27], s77 offen sc0 sc1
    buffer_load_dwordx4 v[196:199], v4, s[92:95], s84 offen offset:1024 sc1
    s_cmp_lt_u32 s23, 28
    s_cbranch_scc1 Lout_18
    s_waitcnt vmcnt(0)
    buffer_store_dword v14, v15, s[44:47], s80 offen offset:0 sc0 sc1
    s_branch Lend_1
Lout_18:
    s_branch Lp2_4
Lxr_3:
    s_load_dwordx2 s[24:25], s[0:1], 0
    s_load_dwordx2 s[36:37], s[0:1], 32
    s_mov_b32 s74, s52
    s_mul_i32 s48, s74, 13108
    s_lshr_b32 s48, s48, 16
    s_mul_i32 s49, s48, 5
    s_sub_u32 s49, s74, s49
    v_lshrrev_b32 v1, 3, v0
    v_mul_u32_u24 v1, 1280, v1
    v_and_b32 v2, 7, v0
    v_lshrrev_b32 v3, 4, v0
    v_xor_b32 v2, v2, v3
    s_and_b32 s52, s3, 1
    s_lshl_b32 s52, s52, 2
    v_xor_b32 v2, s52, v2
    v_lshl_add_u32 v240, v2, 4, v1
    v_xor_b32 v2, 4, v2
    v_lshl_add_u32 v241, v2, 4, v1
    v_add_u32 v241, 9216, v241
    v_add_u32 v242, 18432, v240
    v_add_u32 v243, 18432, v241
    v_add_u32 v244, 40960, v240
    v_mul_u32_u24 v1, 1280, v3
    v_and_b32 v2, 15, v0
    v_lshlrev_b32 v5, 1, v3
    v_xor_b32 v2, v2, v5
    v_lshl_add_u32 v245, v2, 4, v1
    v_add_u32 v246, 4096, v245
    v_xor_b32 v2, 8, v2
    v_lshl_add_u32 v247, v2, 4, v1
    v_add_u32 v248, 12288, v247
    v_add_u32 v247, 8192, v247
    s_mul_i32 s66, s48, 160
    s_mul_i32 s52, s3, 40
    s_add_u32 s66, s66, s52
    s_mul_i32 s66, s66, 1280
    s_mul_i32 s67, s3, 20480
    s_lshl_b32 s52, s49, 8
    s_add_u32 s67, s67, s52
    s_mul_i32 s68, s3, 5120
    s_lshl_b32 s69, s3, 12
    s_add_u32 s69, s69, 20480
    s_mov_b32 s64, 0
    s_and_b32 s50, s48, 1
    s_mul_i32 s50, s50, 5
    s_lshr_b32 s52, s48, 1
    s_add_u32 s50, s50, s52
    s_lshl_b32 s52, s49, 1
    s_add_u32 s55, s50, s52
    s_mul_i32 s52, s55, 6554
    s_lshr_b32 s52, s52, 16
    s_mul_i32 s50, s52, 10
    s_sub_u32 s50, s55, s50
    s_lshl_b32 s52, s50, 7
    s_add_u32 s66, s66, s52
    s_mul_i32 s52, s50, 81920
    s_add_u32 s67, s67, s52
    s_mov_b32 s26, 2621440
    s_mov_b32 s27, 0x20000
    s_mov_b32 s38, 819200
    s_mov_b32 s39, 0x20000
    s_waitcnt lgkmcnt(0)
    s_add_u32 m0, s68, s64
    s_add_u32 s73, s64, 4096
    buffer_load_dwordx4 v240, s[24:27], s66 offen offset:0 lds
    buffer_load_dwordx4 v241, s[24:27], s66 offen offset:1024 lds
    buffer_load_dwordx4 v242, s[24:27], s66 offen offset:2048 lds
    buffer_load_dwordx4 v243, s[24:27], s66 offen offset:3072 lds
    s_add_u32 m0, s68, s73
    s_nop 0
    buffer_load_dwordx4 v244, s[24:27], s66 offen lds
    s_add_u32 m0, s69, s64
    s_add_u32 s66, s66, 128
    buffer_load_dwordx4 v245, s[36:39], s67 offen offset:0 lds
    buffer_load_dwordx4 v246, s[36:39], s67 offen offset:1024 lds
    buffer_load_dwordx4 v247, s[36:39], s67 offen offset:2048 lds
    buffer_load_dwordx4 v248, s[36:39], s67 offen offset:3072 lds
    s_add_u32 s67, s67, 81920
    s_add_u32 s64, s64, 36864
    s_cmp_ge_u32 s64, 147456
    s_cselect_b32 s64, 0, s64
    s_add_u32 s50, s50, 1
    s_cmp_eq_u32 s50, 10
    s_cselect_b32 s55, 1280, 0
    s_sub_u32 s66, s66, s55
    s_mul_i32 s55, s55, 640
    s_sub_u32 s67, s67, s55
    s_lshr_b32 s52, s3, 1
    s_mul_i32 s52, s52, 10240
    v_and_b32 v1, 15, v0
    v_lshrrev_b32 v5, 1, v1
    v_xor_b32 v5, v5, v3
    v_lshlrev_b32 v1, 7, v1
    v_add_u32 v1, s52, v1
    v_lshl_add_u32 v12, v5, 4, v1
    v_xor_b32 v5, 4, v5
    v_lshl_add_u32 v13, v5, 4, v1
    v_bfe_u32 v1, v0, 2, 2
    v_lshl_add_u32 v2, v3, 3, v1
    v_lshlrev_b32 v2, 8, v2
    v_and_b32 v5, 3, v0
    v_lshl_add_u32 v2, v5, 3, v2
    v_add_u32 v2, 20480, v2
    v_and_b32 v5, 1, v3
    s_and_b32 s52, s3, 1
    v_xor_b32 v5, s52, v5
    v_lshl_add_u32 v1, v5, 2, v1
    v_xor_b32 v5, 0, v1
    v_lshl_add_u32 v8, v5, 5, v2
    v_xor_b32 v5, 1, v1
    v_lshl_add_u32 v9, v5, 5, v2
    v_xor_b32 v5, 2, v1
    v_lshl_add_u32 v10, v5, 5, v2
    v_xor_b32 v5, 3, v1
    v_lshl_add_u32 v11, v5, 5, v2
    s_add_u32 m0, s68, s64
    s_add_u32 s73, s64, 4096
    buffer_load_dwordx4 v240, s[24:27], s66 offen offset:0 lds
    buffer_load_dwordx4 v241, s[24:27], s66 offen offset:1024 lds
    buffer_load_dwordx4 v242, s[24:27], s66 offen offset:2048 lds
    buffer_load_dwordx4 v243, s[24:27], s66 offen offset:3072 lds
    s_add_u32 m0, s68, s73
    s_nop 0
    buffer_load_dwordx4 v244, s[24:27], s66 offen lds
    s_add_u32 m0, s69, s64
    s_add_u32 s66, s66, 128
    buffer_load_dwordx4 v245, s[36:39], s67 offen offset:0 lds
    buffer_load_dwordx4 v246, s[36:39], s67 offen offset:1024 lds
    buffer_load_dwordx4 v247, s[36:39], s67 offen offset:2048 lds
    buffer_load_dwordx4 v248, s[36:39], s67 offen offset:3072 lds
    s_add_u32 s67, s67, 81920
    s_add_u32 s64, s64, 36864
    s_cmp_ge_u32 s64, 147456
    s_cselect_b32 s64, 0, s64
    s_add_u32 s50, s50, 1
    s_cmp_eq_u32 s50, 10
    s_cselect_b32 s55, 1280, 0
    s_sub_u32 s66, s66, s55
    s_mul_i32 s55, s55, 640
    s_sub_u32 s67, s67, s55
    s_waitcnt vmcnt(9)
    s_barrier
    ds_read_b64_tr_b16 v[96:97], v8 offset:0
    ds_read_b64_tr_b16 v[98:99], v8 offset:1024
    ds_read_b64_tr_b16 v[100:101], v9 offset:0
    ds_read_b64_tr_b16 v[102:103], v9 offset:1024
    ds_read_b64_tr_b16 v[104:105], v10 offset:0
    ds_read_b64_tr_b16 v[106:107], v10 offset:1024
    ds_read_b64_tr_b16 v[108:109], v11 offset:0
    ds_read_b64_tr_b16 v[110:111], v11 offset:1024
    ds_read_b128 v[128:131], v12 offset:0
    ds_read_b128 v[132:135], v12 offset:2048
    ds_read_b128 v[136:139], v12 offset:4096
    ds_read_b128 v[140:143], v12 offset:6144
    ds_read_b128 v[144:147], v12 offset:8192
    s_add_u32 s44, s20, 12582912
    s_addc_u32 s45, s21, 0
    s_mov_b32 s46, 1048576
    s_mov_b32 s47, 0x20000
    s_add_u32 m0, s68, s64
    s_add_u32 s73, s64, 4096
    buffer_load_dwordx4 v240, s[24:27], s66 offen offset:0 lds
    buffer_load_dwordx4 v241, s[24:27], s66 offen offset:1024 lds
    buffer_load_dwordx4 v242, s[24:27], s66 offen offset:2048 lds
    buffer_load_dwordx4 v243, s[24:27], s66 offen offset:3072 lds
    s_add_u32 m0, s68, s73
    s_nop 0
    buffer_load_dwordx4 v244, s[24:27], s66 offen lds
    s_mov_b32 s70, 0
    s_mov_b32 s71, 0
    s_waitcnt lgkmcnt(0)
    v_mfma_f32_16x16x32_bf16 v[16:19], v[96:99], v[128:131], 0
    ds_read_b64_tr_b16 v[112:113], v8 offset:8192
    s_add_u32 m0, s69, s64
    s_add_u32 s66, s66, 128
    v_mfma_f32_16x16x32_bf16 v[20:23], v[100:103], v[128:131], 0
    ds_read_b64_tr_b16 v[114:115], v8 offset:9216
    buffer_load_dwordx4 v245, s[36:39], s67 offen offset:0 lds
    v_mfma_f32_16x16x32_bf16 v[24:27], v[104:107], v[128:131], 0
    ds_read_b64_tr_b16 v[116:117], v9 offset:8192
    s_add_u32 s71, s71, 36864
    v_mfma_f32_16x16x32_bf16 v[28:31], v[108:111], v[128:131], 0
    ds_read_b64_tr_b16 v[118:119], v9 offset:9216
    s_cmp_ge_u32 s71, 147456
    v_mfma_f32_16x16x32_bf16 v[32:35], v[96:99], v[132:135], 0
    ds_read_b64_tr_b16 v[120:121], v10 offset:8192
    s_mov_b32 s72, 36864
    v_mfma_f32_16x16x32_bf16 v[36:39], v[100:103], v[132:135], 0
    ds_read_b64_tr_b16 v[122:123], v10 offset:9216
    buffer_load_dwordx4 v246, s[36:39], s67 offen offset:1024 lds
    v_mfma_f32_16x16x32_bf16 v[40:43], v[104:107], v[132:135], 0
    ds_read_b64_tr_b16 v[124:125], v11 offset:8192
    s_cselect_b32 s72, 4294856704, s72
    v_mfma_f32_16x16x32_bf16 v[44:47], v[108:111], v[132:135], 0
    ds_read_b64_tr_b16 v[126:127], v11 offset:9216
    s_cselect_b32 s71, 0, s71
    v_mfma_f32_16x16x32_bf16 v[48:51], v[96:99], v[136:139], 0
    ds_read_b128 v[148:151], v13 offset:0
    v_mfma_f32_16x16x32_bf16 v[52:55], v[100:103], v[136:139], 0
    ds_read_b128 v[152:155], v13 offset:2048
    buffer_load_dwordx4 v247, s[36:39], s67 offen offset:2048 lds
    v_mfma_f32_16x16x32_bf16 v[56:59], v[104:107], v[136:139], 0
    ds_read_b128 v[156:159], v13 offset:4096
    v_mfma_f32_16x16x32_bf16 v[60:63], v[108:111], v[136:139], 0
    ds_read_b128 v[160:163], v13 offset:6144
    v_mfma_f32_16x16x32_bf16 v[64:67], v[96:99], v[140:143], 0
    ds_read_b128 v[164:167], v13 offset:8192
    v_mfma_f32_16x16x32_bf16 v[68:71], v[100:103], v[140:143], 0
    v_add_u32 v8, s72, v8
    buffer_load_dwordx4 v248, s[36:39], s67 offen offset:3072 lds
    v_mfma_f32_16x16x32_bf16 v[72:75], v[104:107], v[140:143], 0
    v_add_u32 v9, s72, v9
    s_add_u32 s67, s67, 81920
    s_add_u32 s64, s64, 36864
    v_mfma_f32_16x16x32_bf16 v[76:79], v[108:111], v[140:143], 0
    v_add_u32 v10, s72, v10
    s_cmp_ge_u32 s64, 147456
    s_cselect_b32 s64, 0, s64
    v_mfma_f32_16x16x32_bf16 v[80:83], v[96:99], v[144:147], 0
    v_add_u32 v11, s72, v11
    s_add_u32 s50, s50, 1
    s_cmp_eq_u32 s50, 10
    v_mfma_f32_16x16x32_bf16 v[84:87], v[100:103], v[144:147], 0
    v_add_u32 v12, s72, v12
    s_cselect_b32 s55, 1280, 0
    s_sub_u32 s66, s66, s55
    v_mfma_f32_16x16x32_bf16 v[88:91], v[104:107], v[144:147], 0
    v_add_u32 v13, s72, v13
    s_mul_i32 s55, s55, 640
    v_mfma_f32_16x16x32_bf16 v[92:95], v[108:111], v[144:147], 0
    s_sub_u32 s67, s67, s55
    s_waitcnt vmcnt(9) lgkmcnt(0)
    s_barrier
    v_mfma_f32_16x16x32_bf16 v[16:19], v[112:115], v[148:151], v[16:19]
    ds_read_b64_tr_b16 v[96:97], v8 offset:0
    s_add_u32 m0, s68, s64
    s_add_u32 s73, s64, 4096
    v_mfma_f32_16x16x32_bf16 v[20:23], v[116:119], v[148:151], v[20:23]
    ds_read_b64_tr_b16 v[98:99], v8 offset:1024
    buffer_load_dwordx4 v240, s[24:27], s66 offen offset:0 lds
    v_mfma_f32_16x16x32_bf16 v[24:27], v[120:123], v[148:151], v[24:27]
    ds_read_b64_tr_b16 v[100:101], v9 offset:0
    v_mfma_f32_16x16x32_bf16 v[28:31], v[124:127], v[148:151], v[28:31]
    ds_read_b64_tr_b16 v[102:103], v9 offset:1024
    v_mfma_f32_16x16x32_bf16 v[32:35], v[112:115], v[152:155], v[32:35]
    ds_read_b64_tr_b16 v[104:105], v10 offset:0
    v_mfma_f32_16x16x32_bf16 v[36:39], v[116:119], v[152:155], v[36:39]
    ds_read_b64_tr_b16 v[106:107], v10 offset:1024
    buffer_load_dwordx4 v241, s[24:27], s66 offen offset:1024 lds
    v_mfma_f32_16x16x32_bf16 v[40:43], v[120:123], v[152:155], v[40:43]
    ds_read_b64_tr_b16 v[108:109], v11 offset:0
    v_mfma_f32_16x16x32_bf16 v[44:47], v[124:127], v[152:155], v[44:47]
    ds_read_b64_tr_b16 v[110:111], v11 offset:1024
    v_mfma_f32_16x16x32_bf16 v[48:51], v[112:115], v[156:159], v[48:51]
    ds_read_b128 v[128:131], v12 offset:0
    v_mfma_f32_16x16x32_bf16 v[52:55], v[116:119], v[156:159], v[52:55]
    ds_read_b128 v[132:135], v12 offset:2048
    buffer_load_dwordx4 v242, s[24:27], s66 offen offset:2048 lds
    v_mfma_f32_16x16x32_bf16 v[56:59], v[120:123], v[156:159], v[56:59]
    ds_read_b128 v[136:139], v12 offset:4096
    v_mfma_f32_16x16x32_bf16 v[60:63], v[124:127], v[156:159], v[60:63]
    ds_read_b128 v[140:143], v12 offset:6144
    v_mfma_f32_16x16x32_bf16 v[64:67], v[112:115], v[160:163], v[64:67]
    ds_read_b128 v[144:147], v12 offset:8192
    v_mfma_f32_16x16x32_bf16 v[68:71], v[116:119], v[160:163], v[68:71]
    buffer_load_dwordx4 v243, s[24:27], s66 offen offset:3072 lds
    v_mfma_f32_16x16x32_bf16 v[72:75], v[120:123], v[160:163], v[72:75]
    s_add_u32 m0, s68, s73
    s_nop 0
    v_mfma_f32_16x16x32_bf16 v[76:79], v[124:127], v[160:163], v[76:79]
    v_mfma_f32_16x16x32_bf16 v[80:83], v[112:115], v[164:167], v[80:83]
    v_mfma_f32_16x16x32_bf16 v[84:87], v[116:119], v[164:167], v[84:87]
    buffer_load_dwordx4 v244, s[24:27], s66 offen lds
    v_mfma_f32_16x16x32_bf16 v[88:91], v[120:123], v[164:167], v[88:91]
    v_mfma_f32_16x16x32_bf16 v[92:95], v[124:127], v[164:167], v[92:95]
Lx_19:
    s_waitcnt lgkmcnt(0)
    v_mfma_f32_16x16x32_bf16 v[16:19], v[96:99], v[128:131], v[16:19]
    ds_read_b64_tr_b16 v[112:113], v8 offset:8192
    s_add_u32 m0, s69, s64
    s_add_u32 s66, s66, 128
    v_mfma_f32_16x16x32_bf16 v[20:23], v[100:103], v[128:131], v[20:23]
    ds_read_b64_tr_b16 v[114:115], v8 offset:9216
    buffer_load_dwordx4 v245, s[36:39], s67 offen offset:0 lds
    v_mfma_f32_16x16x32_bf16 v[24:27], v[104:107], v[128:131], v[24:27]
    ds_read_b64_tr_b16 v[116:117], v9 offset:8192
    s_add_u32 s71, s71, 36864
    v_mfma_f32_16x16x32_bf16 v[28:31], v[108:111], v[128:131], v[28:31]
    ds_read_b64_tr_b16 v[118:119], v9 offset:9216
    s_cmp_ge_u32 s71, 147456
    v_mfma_f32_16x16x32_bf16 v[32:35], v[96:99], v[132:135], v[32:35]
    ds_read_b64_tr_b16 v[120:121], v10 offset:8192
    s_mov_b32 s72, 36864
    v_mfma_f32_16x16x32_bf16 v[36:39], v[100:103], v[132:135], v[36:39]
    ds_read_b64_tr_b16 v[122:123], v10 offset:9216
    buffer_load_dwordx4 v246, s[36:39], s67 offen offset:1024 lds
    v_mfma_f32_16x16x32_bf16 v[40:43], v[104:107], v[132:135], v[40:43]
    ds_read_b64_tr_b16 v[124:125], v11 offset:8192
    s_cselect_b32 s72, 4294856704, s72
    v_mfma_f32_16x16x32_bf16 v[44:47], v[108:111], v[132:135], v[44:47]
    ds_read_b64_tr_b16 v[126:127], v11 offset:9216
    s_cselect_b32 s71, 0, s71
    v_mfma_f32_16x16x32_bf16 v[48:51], v[96:99], v[136:139], v[48:51]
    ds_read_b128 v[148:151], v13 offset:0
    v_mfma_f32_16x16x32_bf16 v[52:55], v[100:103], v[136:139], v[52:55]
    ds_read_b128 v[152:155], v13 offset:2048
    buffer_load_dwordx4 v247, s[36:39], s67 offen offset:2048 lds
    v_mfma_f32_16x16x32_bf16 v[56:59], v[104:107], v[136:139], v[56:59]
    ds_read_b128 v[156:159], v13 offset:4096
    v_mfma_f32_16x16x32_bf16 v[60:63], v[108:111], v[136:139], v[60:63]
    ds_read_b128 v[160:163], v13 offset:6144
    v_mfma_f32_16x16x32_bf16 v[64:67], v[96:99], v[140:143], v[64:67]
    ds_read_b128 v[164:167], v13 offset:8192
    v_mfma_f32_16x16x32_bf16 v[68:71], v[100:103], v[140:143], v[68:71]
    v_add_u32 v8, s72, v8
    buffer_load_dwordx4 v248, s[36:39], s67 offen offset:3072 lds
    v_mfma_f32_16x16x32_bf16 v[72:75], v[104:107], v[140:143], v[72:75]
    v_add_u32 v9, s72, v9
    s_add_u32 s67, s67, 81920
    s_add_u32 s64, s64, 36864
    v_mfma_f32_16x16x32_bf16 v[76:79], v[108:111], v[140:143], v[76:79]
    v_add_u32 v10, s72, v10
    s_cmp_ge_u32 s64, 147456
    s_cselect_b32 s64, 0, s64
    v_mfma_f32_16x16x32_bf16 v[80:83], v[96:99], v[144:147], v[80:83]
    v_add_u32 v11, s72, v11
    s_add_u32 s50, s50, 1
    s_cmp_eq_u32 s50, 10
    v_mfma_f32_16x16x32_bf16 v[84:87], v[100:103], v[144:147], v[84:87]
    v_add_u32 v12, s72, v12
    s_cselect_b32 s55, 1280, 0
    s_sub_u32 s66, s66, s55
    v_mfma_f32_16x16x32_bf16 v[88:91], v[104:107], v[144:147], v[88:91]
    v_add_u32 v13, s72, v13
    s_mul_i32 s55, s55, 640
    v_mfma_f32_16x16x32_bf16 v[92:95], v[108:111], v[144:147], v[92:95]
    s_sub_u32 s67, s67, s55
    s_waitcnt vmcnt(9) lgkmcnt(0)
    s_barrier
    v_mfma_f32_16x16x32_bf16 v[16:19], v[112:115], v[148:151], v[16:19]
    ds_read_b64_tr_b16 v[96:97], v8 offset:0
    s_add_u32 m0, s68, s64
    s_add_u32 s73, s64, 4096
    v_mfma_f32_16x16x32_bf16 v[20:23], v[116:119], v[148:151], v[20:23]
    ds_read_b64_tr_b16 v[98:99], v8 offset:1024
    buffer_load_dwordx4 v240, s[24:27], s66 offen offset:0 lds
    v_mfma_f32_16x16x32_bf16 v[24:27], v[120:123], v[148:151], v[24:27]
    ds_read_b64_tr_b16 v[100:101], v9 offset:0
    v_mfma_f32_16x16x32_bf16 v[28:31], v[124:127], v[148:151], v[28:31]
    ds_read_b64_tr_b16 v[102:103], v9 offset:1024
    v_mfma_f32_16x16x32_bf16 v[32:35], v[112:115], v[152:155], v[32:35]
    ds_read_b64_tr_b16 v[104:105], v10 offset:0
    v_mfma_f32_16x16x32_bf16 v[36:39], v[116:119], v[152:155], v[36:39]
    ds_read_b64_tr_b16 v[106:107], v10 offset:1024
    buffer_load_dwordx4 v241, s[24:27], s66 offen offset:1024 lds
    v_mfma_f32_16x16x32_bf16 v[40:43], v[120:123], v[152:155], v[40:43]
    ds_read_b64_tr_b16 v[108:109], v11 offset:0
    v_mfma_f32_16x16x32_bf16 v[44:47], v[124:127], v[152:155], v[44:47]
    ds_read_b64_tr_b16 v[110:111], v11 offset:1024
    v_mfma_f32_16x16x32_bf16 v[48:51], v[112:115], v[156:159], v[48:51]
    ds_read_b128 v[128:131], v12 offset:0
    v_mfma_f32_16x16x32_bf16 v[52:55], v[116:119], v[156:159], v[52:55]
    ds_read_b128 v[132:135], v12 offset:2048
    buffer_load_dwordx4 v242, s[24:27], s66 offen offset:2048 lds
    v_mfma_f32_16x16x32_bf16 v[56:59], v[120:123], v[156:159], v[56:59]
    ds_read_b128 v[136:139], v12 offset:4096
    v_mfma_f32_16x16x32_bf16 v[60:63], v[124:127], v[156:159], v[60:63]
    ds_read_b128 v[140:143], v12 offset:6144
    v_mfma_f32_16x16x32_bf16 v[64:67], v[112:115], v[160:163], v[64:67]
    ds_read_b128 v[144:147], v12 offset:8192
    v_mfma_f32_16x16x32_bf16 v[68:71], v[116:119], v[160:163], v[68:71]
    buffer_load_dwordx4 v243, s[24:27], s66 offen offset:3072 lds
    v_mfma_f32_16x16x32_bf16 v[72:75], v[120:123], v[160:163], v[72:75]
    s_add_u32 m0, s68, s73
    s_nop 0
    v_mfma_f32_16x16x32_bf16 v[76:79], v[124:127], v[160:163], v[76:79]
    v_mfma_f32_16x16x32_bf16 v[80:83], v[112:115], v[164:167], v[80:83]
    v_mfma_f32_16x16x32_bf16 v[84:87], v[116:119], v[164:167], v[84:87]
    buffer_load_dwordx4 v244, s[24:27], s66 offen lds
    v_mfma_f32_16x16x32_bf16 v[88:91], v[120:123], v[164:167], v[88:91]
    v_mfma_f32_16x16x32_bf16 v[92:95], v[124:127], v[164:167], v[92:95]
    s_add_u32 s70, s70, 1
    s_cmp_lt_u32 s70, 6
    s_cbranch_scc1 Lx_19
    s_waitcnt lgkmcnt(0)
    v_mfma_f32_16x16x32_bf16 v[16:19], v[96:99], v[128:131], v[16:19]
    ds_read_b64_tr_b16 v[112:113], v8 offset:8192
    s_add_u32 m0, s69, s64
    s_add_u32 s66, s66, 128
    v_mfma_f32_16x16x32_bf16 v[20:23], v[100:103], v[128:131], v[20:23]
    ds_read_b64_tr_b16 v[114:115], v8 offset:9216
    buffer_load_dwordx4 v245, s[36:39], s67 offen offset:0 lds
    v_mfma_f32_16x16x32_bf16 v[24:27], v[104:107], v[128:131], v[24:27]
    ds_read_b64_tr_b16 v[116:117], v9 offset:8192
    s_add_u32 s71, s71, 36864
    v_mfma_f32_16x16x32_bf16 v[28:31], v[108:111], v[128:131], v[28:31]
    ds_read_b64_tr_b16 v[118:119], v9 offset:9216
    s_cmp_ge_u32 s71, 147456
    v_mfma_f32_16x16x32_bf16 v[32:35], v[96:99], v[132:135], v[32:35]
    ds_read_b64_tr_b16 v[120:121], v10 offset:8192
    s_mov_b32 s72, 36864
    v_mfma_f32_16x16x32_bf16 v[36:39], v[100:103], v[132:135], v[36:39]
    ds_read_b64_tr_b16 v[122:123], v10 offset:9216
    buffer_load_dwordx4 v246, s[36:39], s67 offen offset:1024 lds
    v_mfma_f32_16x16x32_bf16 v[40:43], v[104:107], v[132:135], v[40:43]
    ds_read_b64_tr_b16 v[124:125], v11 offset:8192
    s_cselect_b32 s72, 4294856704, s72
    v_mfma_f32_16x16x32_bf16 v[44:47], v[108:111], v[132:135], v[44:47]
    ds_read_b64_tr_b16 v[126:127], v11 offset:9216
    s_cselect_b32 s71, 0, s71
    v_mfma_f32_16x16x32_bf16 v[48:51], v[96:99], v[136:139], v[48:51]
    ds_read_b128 v[148:151], v13 offset:0
    v_mfma_f32_16x16x32_bf16 v[52:55], v[100:103], v[136:139], v[52:55]
    ds_read_b128 v[152:155], v13 offset:2048
    buffer_load_dwordx4 v247, s[36:39], s67 offen offset:2048 lds
    v_mfma_f32_16x16x32_bf16 v[56:59], v[104:107], v[136:139], v[56:59]
    ds_read_b128 v[156:159], v13 offset:4096
    v_mfma_f32_16x16x32_bf16 v[60:63], v[108:111], v[136:139], v[60:63]
    ds_read_b128 v[160:163], v13 offset:6144
    v_mfma_f32_16x16x32_bf16 v[64:67], v[96:99], v[140:143], v[64:67]
    ds_read_b128 v[164:167], v13 offset:8192
    v_mfma_f32_16x16x32_bf16 v[68:71], v[100:103], v[140:143], v[68:71]
    v_add_u32 v8, s72, v8
    buffer_load_dwordx4 v248, s[36:39], s67 offen offset:3072 lds
    v_mfma_f32_16x16x32_bf16 v[72:75], v[104:107], v[140:143], v[72:75]
    v_add_u32 v9, s72, v9
    s_add_u32 s67, s67, 81920
    s_add_u32 s64, s64, 36864
    v_mfma_f32_16x16x32_bf16 v[76:79], v[108:111], v[140:143], v[76:79]
    v_add_u32 v10, s72, v10
    s_cmp_ge_u32 s64, 147456
    s_cselect_b32 s64, 0, s64
    v_mfma_f32_16x16x32_bf16 v[80:83], v[96:99], v[144:147], v[80:83]
    v_add_u32 v11, s72, v11
    s_add_u32 s50, s50, 1
    s_cmp_eq_u32 s50, 10
    v_mfma_f32_16x16x32_bf16 v[84:87], v[100:103], v[144:147], v[84:87]
    v_add_u32 v12, s72, v12
    s_cselect_b32 s55, 1280, 0
    s_sub_u32 s66, s66, s55
    v_mfma_f32_16x16x32_bf16 v[88:91], v[104:107], v[144:147], v[88:91]
    v_add_u32 v13, s72, v13
    s_mul_i32 s55, s55, 640
    v_mfma_f32_16x16x32_bf16 v[92:95], v[108:111], v[144:147], v[92:95]
    s_sub_u32 s67, s67, s55
    s_waitcnt vmcnt(9) lgkmcnt(0)
    s_barrier
    v_mfma_f32_16x16x32_bf16 v[16:19], v[112:115], v[148:151], v[16:19]
    ds_read_b64_tr_b16 v[96:97], v8 offset:0
    s_and_b32 s4, s22, 3
    s_lshl_b32 s4, s4, 2
    s_and_b32 s52, s23, 3
    v_mfma_f32_16x16x32_bf16 v[20:23], v[116:119], v[148:151], v[20:23]
    ds_read_b64_tr_b16 v[98:99], v8 offset:1024
    s_add_u32 s4, s4, s52
    s_lshr_b32 s5, s22, 2
    s_mul_i32 s5, s5, 7
    v_mfma_f32_16x16x32_bf16 v[24:27], v[120:123], v[148:151], v[24:27]
    ds_read_b64_tr_b16 v[100:101], v9 offset:0
    s_lshr_b32 s52, s23, 2
    s_add_u32 s5, s5, s52
    s_min_u32 s5, s5, 13
    v_mfma_f32_16x16x32_bf16 v[28:31], v[124:127], v[148:151], v[28:31]
    ds_read_b64_tr_b16 v[102:103], v9 offset:1024
    s_lshl_b32 s52, s4, 2
    s_add_u32 s52, s52, s3
    s_mul_i32 s53, s52, 40960
    v_mfma_f32_16x16x32_bf16 v[32:35], v[112:115], v[152:155], v[32:35]
    ds_read_b64_tr_b16 v[104:105], v10 offset:0
    s_add_u32 s53, s53, 8388608
    s_add_u32 s92, s20, s53
    s_addc_u32 s93, s21, 0
    v_mfma_f32_16x16x32_bf16 v[36:39], v[116:119], v[152:155], v[36:39]
    ds_read_b64_tr_b16 v[106:107], v10 offset:1024
    s_mov_b32 s94, 40960
    s_mov_b32 s95, 0x20000
    s_mul_i32 s52, s52, 13108
    v_mfma_f32_16x16x32_bf16 v[40:43], v[120:123], v[152:155], v[40:43]
    ds_read_b64_tr_b16 v[108:109], v11 offset:0
    s_lshr_b32 s52, s52, 16
    s_mul_i32 s7, s52, 640
    v_mfma_f32_16x16x32_bf16 v[44:47], v[124:127], v[152:155], v[44:47]
    ds_read_b64_tr_b16 v[110:111], v11 offset:1024
    s_add_u32 s7, s7, 524288
    s_lshl_b32 s52, s5, 2
    v_mfma_f32_16x16x32_bf16 v[48:51], v[112:115], v[156:159], v[48:51]
    ds_read_b128 v[128:131], v12 offset:0
    s_add_u32 s52, s52, s3
    s_mul_i32 s53, s52, 40960
    v_mfma_f32_16x16x32_bf16 v[52:55], v[116:119], v[156:159], v[52:55]
    ds_read_b128 v[132:135], v12 offset:2048
    s_mov_b32 s14, 40960
    s_add_u32 s53, s53, 4194304
    v_mfma_f32_16x16x32_bf16 v[56:59], v[120:123], v[156:159], v[56:59]
    ds_read_b128 v[136:139], v12 offset:4096
    s_add_u32 s12, s20, s53
    s_addc_u32 s13, s21, 0
    v_mfma_f32_16x16x32_bf16 v[60:63], v[124:127], v[156:159], v[60:63]
    ds_read_b128 v[140:143], v12 offset:6144
    s_mov_b32 s15, 0x20000
    s_mul_i32 s8, s52, 6144
    v_mfma_f32_16x16x32_bf16 v[64:67], v[112:115], v[160:163], v[64:67]
    ds_read_b128 v[144:147], v12 offset:8192
    s_add_u32 s8, s8, 131072
    s_add_u32 s9, s8, 2048
    v_mfma_f32_16x16x32_bf16 v[68:71], v[116:119], v[160:163], v[68:71]
    s_add_u32 s10, s8, 4096
    s_mul_i32 s58, s3, 40960
    v_mfma_f32_16x16x32_bf16 v[72:75], v[120:123], v[160:163], v[72:75]
    s_add_u32 s52, s4, s5
    s_and_b32 s52, s52, 1
    v_mfma_f32_16x16x32_bf16 v[76:79], v[124:127], v[160:163], v[76:79]
    s_mul_i32 s18, s52, 6144
    s_mul_i32 s19, s52, -8192
    v_mfma_f32_16x16x32_bf16 v[80:83], v[112:115], v[164:167], v[80:83]
    s_mul_i32 s6, s52, -6144
    s_cmp_ge_u32 s23, 28
    v_mfma_f32_16x16x32_bf16 v[84:87], v[116:119], v[164:167], v[84:87]
    s_cselect_b32 s14, 0, s14
    s_cselect_b32 s94, 0, s94
    v_mfma_f32_16x16x32_bf16 v[88:91], v[120:123], v[164:167], v[88:91]
    s_add_u32 s28, s20, 8388608
    s_addc_u32 s29, s21, 0
    v_mfma_f32_16x16x32_bf16 v[92:95], v[124:127], v[164:167], v[92:95]
    s_mov_b32 s30, 2621440
    s_mov_b32 s31, 0x20000
    s_waitcnt lgkmcnt(0)
    v_mfma_f32_16x16x32_bf16 v[16:19], v[96:99], v[128:131], v[16:19]
    ds_read_b64_tr_b16 v[112:113], v8 offset:8192
    v_mfma_f32_16x16x32_bf16 v[20:23], v[100:103], v[128:131], v[20:23]
    ds_read_b64_tr_b16 v[114:115], v8 offset:9216
    v_mfma_f32_16x16x32_bf16 v[24:27], v[104:107], v[128:131], v[24:27]
    ds_read_b64_tr_b16 v[116:117], v9 offset:8192
    s_add_u32 s71, s71, 36864
    v_mfma_f32_16x16x32_bf16 v[28:31], v[108:111], v[128:131], v[28:31]
    ds_read_b64_tr_b16 v[118:119], v9 offset:9216
    s_cmp_ge_u32 s71, 147456
    v_mfma_f32_16x16x32_bf16 v[32:35], v[96:99], v[132:135], v[32:35]
    ds_read_b64_tr_b16 v[120:121], v10 offset:8192
    s_mov_b32 s72, 36864
    v_mfma_f32_16x16x32_bf16 v[36:39], v[100:103], v[132:135], v[36:39]
    ds_read_b64_tr_b16 v[122:123], v10 offset:9216
    s_cselect_b32 s72, 4294856704, s72
    v_mfma_f32_16x16x32_bf16 v[40:43], v[104:107], v[132:135], v[40:43]
    ds_read_b64_tr_b16 v[124:125], v11 offset:8192
    s_cselect_b32 s71, 0, s71
    v_mfma_f32_16x16x32_bf16 v[44:47], v[108:111], v[132:135], v[44:47]
    ds_read_b64_tr_b16 v[126:127], v11 offset:9216
    s_mul_i32 s52, s48, 10
    s_lshr_b32 s53, s3, 1
    s_mul_i32 s53, s53, 5
    v_mfma_f32_16x16x32_bf16 v[48:51], v[96:99], v[136:139], v[48:51]
    ds_read_b128 v[148:151], v13 offset:0
    s_add_u32 s52, s52, s53
    s_add_u32 s53, s52, 0
    s_lshr_b32 s54, s53, 1
    v_mfma_f32_16x16x32_bf16 v[52:55], v[100:103], v[136:139], v[52:55]
    ds_read_b128 v[152:155], v13 offset:2048
    s_mul_i32 s54, s54, 40960
    s_and_b32 s53, s53, 1
    v_mfma_f32_16x16x32_bf16 v[56:59], v[104:107], v[136:139], v[56:59]
    ds_read_b128 v[156:159], v13 offset:4096
    s_lshl_b32 s53, s53, 10
    s_add_u32 s60, s53, s54
    v_mfma_f32_16x16x32_bf16 v[60:63], v[108:111], v[136:139], v[60:63]
    ds_read_b128 v[160:163], v13 offset:6144
    s_add_u32 s53, s52, 1
    s_lshr_b32 s54, s53, 1
    v_mfma_f32_16x16x32_bf16 v[64:67], v[96:99], v[140:143], v[64:67]
    ds_read_b128 v[164:167], v13 offset:8192
    s_mul_i32 s54, s54, 40960
    s_and_b32 s53, s53, 1
    v_mfma_f32_16x16x32_bf16 v[68:71], v[100:103], v[140:143], v[68:71]
    v_add_u32 v8, s72, v8
    s_lshl_b32 s53, s53, 10
    s_add_u32 s61, s53, s54
    v_mfma_f32_16x16x32_bf16 v[72:75], v[104:107], v[140:143], v[72:75]
    v_add_u32 v9, s72, v9
    s_add_u32 s53, s52, 2
    s_lshr_b32 s54, s53, 1
    v_mfma_f32_16x16x32_bf16 v[76:79], v[108:111], v[140:143], v[76:79]
    v_add_u32 v10, s72, v10
    s_mul_i32 s54, s54, 40960
    s_and_b32 s53, s53, 1
    v_mfma_f32_16x16x32_bf16 v[80:83], v[96:99], v[144:147], v[80:83]
    v_add_u32 v11, s72, v11
    s_lshl_b32 s53, s53, 10
    s_add_u32 s62, s53, s54
    v_mfma_f32_16x16x32_bf16 v[84:87], v[100:103], v[144:147], v[84:87]
    v_add_u32 v12, s72, v12
    s_add_u32 s53, s52, 3
    s_lshr_b32 s54, s53, 1
    v_mfma_f32_16x16x32_bf16 v[88:91], v[104:107], v[144:147], v[88:91]
    v_add_u32 v13, s72, v13
    s_mul_i32 s54, s54, 40960
    s_and_b32 s53, s53, 1
    v_mfma_f32_16x16x32_bf16 v[92:95], v[108:111], v[144:147], v[92:95]
    s_lshl_b32 s53, s53, 10
    s_add_u32 s63, s53, s54
    s_waitcnt vmcnt(0) lgkmcnt(0)
    s_barrier
    v_mfma_f32_16x16x32_bf16 v[16:19], v[112:115], v[148:151], v[16:19]
    ds_read_b64_tr_b16 v[96:97], v8 offset:0
    s_add_u32 s53, s52, 4
    s_lshr_b32 s54, s53, 1
    v_mfma_f32_16x16x32_bf16 v[20:23], v[116:119], v[148:151], v[20:23]
    ds_read_b64_tr_b16 v[98:99], v8 offset:1024
    s_mul_i32 s54, s54, 40960
    s_and_b32 s53, s53, 1
    v_mfma_f32_16x16x32_bf16 v[24:27], v[120:123], v[148:151], v[24:27]
    ds_read_b64_tr_b16 v[100:101], v9 offset:0
    s_lshl_b32 s53, s53, 10
    s_add_u32 s65, s53, s54
    v_mfma_f32_16x16x32_bf16 v[28:31], v[124:127], v[148:151], v[28:31]
    ds_read_b64_tr_b16 v[102:103], v9 offset:1024
    s_lshl_b32 s52, s49, 2
    s_and_b32 s53, s3, 1
    v_mfma_f32_16x16x32_bf16 v[32:35], v[112:115], v[152:155], v[32:35]
    ds_read_b64_tr_b16 v[104:105], v10 offset:0
    s_lshl_b32 s53, s53, 1
    s_add_u32 s52, s52, s53
    v_mfma_f32_16x16x32_bf16 v[36:39], v[116:119], v[152:155], v[36:39]
    ds_read_b64_tr_b16 v[106:107], v10 offset:1024
    s_add_u32 s53, s52, 0
    s_mul_i32 s54, s53, 21846
    v_mfma_f32_16x16x32_bf16 v[40:43], v[120:123], v[152:155], v[40:43]
    ds_read_b64_tr_b16 v[108:109], v11 offset:0
    s_lshr_b32 s54, s54, 16
    s_mul_i32 s55, s54, 3
    v_mfma_f32_16x16x32_bf16 v[44:47], v[124:127], v[152:155], v[44:47]
    ds_read_b64_tr_b16 v[110:111], v11 offset:1024
    s_sub_u32 s55, s53, s55
    s_mul_i32 s55, s55, 7
    v_mfma_f32_16x16x32_bf16 v[48:51], v[112:115], v[156:159], v[48:51]
    ds_read_b128 v[128:131], v12 offset:0
    s_add_u32 s55, s55, s54
    s_lshl_b32 s55, s55, 11
    v_mfma_f32_16x16x32_bf16 v[52:55], v[116:119], v[156:159], v[52:55]
    ds_read_b128 v[132:135], v12 offset:2048
    v_add_u32 v2, s55, v4
    s_add_u32 s53, s52, 1
    v_mfma_f32_16x16x32_bf16 v[56:59], v[120:123], v[156:159], v[56:59]
    ds_read_b128 v[136:139], v12 offset:4096
    s_mul_i32 s54, s53, 21846
    s_lshr_b32 s54, s54, 16
    v_mfma_f32_16x16x32_bf16 v[60:63], v[124:127], v[156:159], v[60:63]
    ds_read_b128 v[140:143], v12 offset:6144
    s_mul_i32 s55, s54, 3
    s_sub_u32 s55, s53, s55
    v_mfma_f32_16x16x32_bf16 v[64:67], v[112:115], v[160:163], v[64:67]
    ds_read_b128 v[144:147], v12 offset:8192
    s_mul_i32 s55, s55, 7
    v_mfma_f32_16x16x32_bf16 v[68:71], v[116:119], v[160:163], v[68:71]
    s_add_u32 s55, s55, s54
    v_mfma_f32_16x16x32_bf16 v[72:75], v[120:123], v[160:163], v[72:75]
    s_lshl_b32 s55, s55, 11
    v_mfma_f32_16x16x32_bf16 v[76:79], v[124:127], v[160:163], v[76:79]
    v_add_u32 v3, s55, v4
    v_mfma_f32_16x16x32_bf16 v[80:83], v[112:115], v[164:167], v[80:83]
    s_lshl_b32 s83, s74, 7
    v_mfma_f32_16x16x32_bf16 v[84:87], v[116:119], v[164:167], v[84:87]
    s_lshl_b32 s52, s3, 7
    v_mfma_f32_16x16x32_bf16 v[88:91], v[120:123], v[164:167], v[88:91]
    s_add_u32 s83, s83, 0
    v_mfma_f32_16x16x32_bf16 v[92:95], v[124:127], v[164:167], v[92:95]
    s_add_u32 s83, s83, 524288
    s_waitcnt lgkmcnt(0)
    v_mfma_f32_16x16x32_bf16 v[16:19], v[96:99], v[128:131], v[16:19]
    ds_read_b64_tr_b16 v[112:113], v8 offset:8192
    v_mfma_f32_16x16x32_bf16 v[20:23], v[100:103], v[128:131], v[20:23]
    ds_read_b64_tr_b16 v[114:115], v8 offset:9216
    v_mfma_f32_16x16x32_bf16 v[24:27], v[104:107], v[128:131], v[24:27]
    ds_read_b64_tr_b16 v[116:117], v9 offset:8192
    v_mfma_f32_16x16x32_bf16 v[28:31], v[108:111], v[128:131], v[28:31]
    ds_read_b64_tr_b16 v[118:119], v9 offset:9216
    v_mfma_f32_16x16x32_bf16 v[32:35], v[96:99], v[132:135], v[32:35]
    ds_read_b64_tr_b16 v[120:121], v10 offset:8192
    v_mfma_f32_16x16x32_bf16 v[36:39], v[100:103], v[132:135], v[36:39]
    ds_read_b64_tr_b16 v[122:123], v10 offset:9216
    v_mfma_f32_16x16x32_bf16 v[40:43], v[104:107], v[132:135], v[40:43]
    ds_read_b64_tr_b16 v[124:125], v11 offset:8192
    v_mfma_f32_16x16x32_bf16 v[44:47], v[108:111], v[132:135], v[44:47]
    ds_read_b64_tr_b16 v[126:127], v11 offset:9216
    v_mfma_f32_16x16x32_bf16 v[48:51], v[96:99], v[136:139], v[48:51]
    ds_read_b128 v[148:151], v13 offset:0
    v_mfma_f32_16x16x32_bf16 v[52:55], v[100:103], v[136:139], v[52:55]
    ds_read_b128 v[152:155], v13 offset:2048
    v_mfma_f32_16x16x32_bf16 v[56:59], v[104:107], v[136:139], v[56:59]
    ds_read_b128 v[156:159], v13 offset:4096
    v_mfma_f32_16x16x32_bf16 v[60:63], v[108:111], v[136:139], v[60:63]
    ds_read_b128 v[160:163], v13 offset:6144
    v_mfma_f32_16x16x32_bf16 v[64:67], v[96:99], v[140:143], v[64:67]
    ds_read_b128 v[164:167], v13 offset:8192
    v_mfma_f32_16x16x32_bf16 v[68:71], v[100:103], v[140:143], v[68:71]
    v_mfma_f32_16x16x32_bf16 v[72:75], v[104:107], v[140:143], v[72:75]
    v_mfma_f32_16x16x32_bf16 v[76:79], v[108:111], v[140:143], v[76:79]
    v_mfma_f32_16x16x32_bf16 v[80:83], v[96:99], v[144:147], v[80:83]
    v_mfma_f32_16x16x32_bf16 v[84:87], v[100:103], v[144:147], v[84:87]
    v_mfma_f32_16x16x32_bf16 v[88:91], v[104:107], v[144:147], v[88:91]
    v_mfma_f32_16x16x32_bf16 v[92:95], v[108:111], v[144:147], v[92:95]
    s_waitcnt lgkmcnt(0)
    s_load_dword s87, s[88:89], 0
    v_mfma_f32_16x16x32_bf16 v[16:19], v[112:115], v[148:151], v[16:19]
    v_mfma_f32_16x16x32_bf16 v[20:23], v[116:119], v[148:151], v[20:23]
    v_mfma_f32_16x16x32_bf16 v[24:27], v[120:123], v[148:151], v[24:27]
    v_mfma_f32_16x16x32_bf16 v[28:31], v[124:127], v[148:151], v[28:31]
    v_mfma_f32_16x16x32_bf16 v[32:35], v[112:115], v[152:155], v[32:35]
    v_mfma_f32_16x16x32_bf16 v[36:39], v[116:119], v[152:155], v[36:39]
    v_mfma_f32_16x16x32_bf16 v[40:43], v[120:123], v[152:155], v[40:43]
    v_mfma_f32_16x16x32_bf16 v[44:47], v[124:127], v[152:155], v[44:47]
    v_mfma_f32_16x16x32_bf16 v[48:51], v[112:115], v[156:159], v[48:51]
    v_mfma_f32_16x16x32_bf16 v[52:55], v[116:119], v[156:159], v[52:55]
    v_mfma_f32_16x16x32_bf16 v[56:59], v[120:123], v[156:159], v[56:59]
    v_mfma_f32_16x16x32_bf16 v[60:63], v[124:127], v[156:159], v[60:63]
    v_cvt_pk_bf16_f32 v168, v16, v17
    v_cvt_pk_bf16_f32 v169, v18, v19
    v_cvt_pk_bf16_f32 v170, v20, v21
    v_mfma_f32_16x16x32_bf16 v[64:67], v[112:115], v[160:163], v[64:67]
    v_cvt_pk_bf16_f32 v171, v22, v23
    buffer_store_dwordx4 v[168:171], v2, s[28:31], s60 offen sc0 sc1
    v_cvt_pk_bf16_f32 v172, v24, v25
    v_mfma_f32_16x16x32_bf16 v[68:71], v[116:119], v[160:163], v[68:71]
    v_cvt_pk_bf16_f32 v173, v26, v27
    v_cvt_pk_bf16_f32 v174, v28, v29
    v_cvt_pk_bf16_f32 v175, v30, v31
    v_mfma_f32_16x16x32_bf16 v[72:75], v[120:123], v[160:163], v[72:75]
    buffer_store_dwordx4 v[172:175], v3, s[28:31], s60 offen sc0 sc1
    v_mfma_f32_16x16x32_bf16 v[76:79], v[124:127], v[160:163], v[76:79]
    v_cvt_pk_bf16_f32 v176, v32, v33
    v_cvt_pk_bf16_f32 v177, v34, v35
    v_cvt_pk_bf16_f32 v178, v36, v37
    v_mfma_f32_16x16x32_bf16 v[80:83], v[112:115], v[164:167], v[80:83]
    v_cvt_pk_bf16_f32 v179, v38, v39
    buffer_store_dwordx4 v[176:179], v2, s[28:31], s61 offen sc0 sc1
    v_cvt_pk_bf16_f32 v180, v40, v41
    v_mfma_f32_16x16x32_bf16 v[84:87], v[116:119], v[164:167], v[84:87]
    v_cvt_pk_bf16_f32 v181, v42, v43
    v_cvt_pk_bf16_f32 v182, v44, v45
    v_cvt_pk_bf16_f32 v183, v46, v47
    v_mfma_f32_16x16x32_bf16 v[88:91], v[120:123], v[164:167], v[88:91]
    buffer_store_dwordx4 v[180:183], v3, s[28:31], s61 offen sc0 sc1
    v_mfma_f32_16x16x32_bf16 v[92:95], v[124:127], v[164:167], v[92:95]
    v_cvt_pk_bf16_f32 v184, v48, v49
    v_cvt_pk_bf16_f32 v185, v50, v51
    v_cvt_pk_bf16_f32 v186, v52, v53
    v_cvt_pk_bf16_f32 v187, v54, v55
    s_waitcnt vmcnt(3)
    buffer_store_dwordx4 v[184:187], v2, s[28:31], s62 offen sc0 sc1
    v_cvt_pk_bf16_f32 v188, v56, v57
    v_cvt_pk_bf16_f32 v189, v58, v59
    v_cvt_pk_bf16_f32 v190, v60, v61
    v_cvt_pk_bf16_f32 v191, v62, v63
    s_waitcnt vmcnt(3)
    buffer_store_dwordx4 v[188:191], v3, s[28:31], s62 offen sc0 sc1
    v_cvt_pk_bf16_f32 v192, v64, v65
    v_cvt_pk_bf16_f32 v193, v66, v67
    v_cvt_pk_bf16_f32 v194, v68, v69
    v_cvt_pk_bf16_f32 v195, v70, v71
    s_waitcnt vmcnt(3)
    buffer_store_dwordx4 v[192:195], v2, s[28:31], s63 offen sc0 sc1
    v_cvt_pk_bf16_f32 v196, v72, v73
    v_cvt_pk_bf16_f32 v197, v74, v75
    v_cvt_pk_bf16_f32 v198, v76, v77
    v_cvt_pk_bf16_f32 v199, v78, v79
    s_waitcnt vmcnt(3)
    buffer_store_dwordx4 v[196:199], v3, s[28:31], s63 offen sc0 sc1
    v_cvt_pk_bf16_f32 v200, v80, v81
    v_cvt_pk_bf16_f32 v201, v82, v83
    v_cvt_pk_bf16_f32 v202, v84, v85
    v_cvt_pk_bf16_f32 v203, v86, v87
    s_waitcnt vmcnt(3)
    buffer_store_dwordx4 v[200:203], v2, s[28:31], s65 offen sc0 sc1
    v_cvt_pk_bf16_f32 v204, v88, v89
    v_cvt_pk_bf16_f32 v205, v90, v91
    v_cvt_pk_bf16_f32 v206, v92, v93
    v_cvt_pk_bf16_f32 v207, v94, v95
    s_waitcnt vmcnt(3)
    buffer_store_dwordx4 v[204:207], v3, s[28:31], s65 offen sc0 sc1
    v_add_u32 v242, 40960, v4
    v_add_u32 v243, 81920, v4
    v_add_u32 v10, 122880, v4
    s_cmp_eq_u32 s5, 13
    s_cselect_b32 s52, 6, 13
    s_cselect_b32 s53, 1073741824, 0
    v_add_u32 v240, s53, v4
    v_min_u32 v248, s52, v0
    v_lshlrev_b32 v248, 7, v248
    v_min_u32 v241, 4, v0
    v_lshlrev_b32 v241, 7, v241
    v_subrev_u32 v1, 14, v0
    v_min_u32 v1, 4, v1
    v_lshlrev_b32 v1, 7, v1
    v_add_u32 v1, s7, v1
    v_add_u32 v249, s8, v248
    v_cmp_gt_u32 vcc, 14, v0
    s_mov_b32 s11, 0
    s_nop 0
    v_cndmask_b32 v249, v1, v249, vcc
    v_and_b32 v1, 15, v0
    v_lshrrev_b32 v2, 4, v0
    v_lshlrev_b32 v2, 1, v2
    v_and_b32 v3, 7, v0
    v_xor_b32 v2, v2, v3
    v_lshlrev_b32 v1, 7, v1
    v_add_u32 v1, s58, v1
    v_lshl_add_u32 v11, v2, 4, v1
    v_xor_b32 v2, 1, v2
    v_lshl_add_u32 v12, v2, 4, v1
    v_lshrrev_b32 v1, 3, v0
    v_xor_b32 v2, v1, v3
    v_mul_u32_u24 v1, 3456, v1
    v_lshl_add_u32 v5, v2, 4, v1
    v_add_u32 v13, s58, v4
    s_mov_b32 s80, 1073741824
    s_mov_b32 s51, 0
    s_waitcnt vmcnt(0)
    s_waitcnt lgkmcnt(0)
    s_cmp_lg_u32 s87, 0
    s_cbranch_scc1 Ltk_21
    s_mov_b32 s86, 0
    v_mov_b32 v15, 0
Ltk_20:
    buffer_load_dword v14, v15, s[88:91], 0 offen sc0 sc1
    s_add_u32 s86, s86, 1
    s_cmp_gt_u32 s86, 524288
    s_cbranch_scc1 Lend_1
    s_waitcnt vmcnt(0)
    v_readfirstlane_b32 s87, v14
    s_nop 3
    s_cmp_lg_u32 s87, 0
    s_cbranch_scc0 Ltk_20
Ltk_21:
    v_mov_b32 v14, s87
    v_lshlrev_b32 v15, 2, v0
    v_and_b32 v1, 32, v0
    v_lshl_add_u32 v15, v1, 24, v15
    s_barrier
    s_cmp_lg_u32 s3, 0
    s_cbranch_scc1 Lfs_22
    buffer_store_dword v14, v15, s[44:47], s83 offen offset:0 sc0 sc1
Lfs_22:
    s_cmp_ge_u32 s23, 28
    s_cbranch_scc1 Lend_1
    s_mov_b32 s32, s16
    s_mov_b32 s33, s17
    s_mov_b32 s34, 7077888
    s_mov_b32 s35, 0x20000
    s_lshl_b32 s52, s4, 7
    s_lshl_b32 s53, s3, 5
    s_add_u32 s52, s52, s53
    s_mul_i32 s52, s52, 3456
    s_lshl_b32 s53, s5, 8
    s_add_u32 s60, s52, s53
    s_add_u32 s61, s60, 27648
    s_add_u32 s62, s60, 55296
    s_add_u32 s63, s60, 82944
    s_add_u32 s64, s60, 128
    s_cmp_eq_u32 s5, 13
    s_cselect_b32 s64, 1073741824, s64
    s_add_u32 s65, s64, 27648
    s_add_u32 s66, s64, 55296
    s_add_u32 s67, s64, 82944
    buffer_load_dword v8, v249, s[44:47], s11 offen offset:0 sc0 sc1
    s_waitcnt vmcnt(0)
    v_cmp_ne_u32 vcc, s87, v8
    s_mov_b32 s86, 0
    s_nop 3
    s_cbranch_vccz Lp_24
Lp_23:
    s_sleep 12
    buffer_load_dword v8, v249, s[44:47], s11 offen offset:0 sc0 sc1
    s_add_u32 s86, s86, 1
    s_cmp_gt_u32 s86, 524288
    s_cbranch_scc1 Lend_1
    s_waitcnt vmcnt(0)
    v_cmp_ne_u32 vcc, s87, v8
    s_nop 4
    s_cbranch_vccnz Lp_23
Lp_24:
    s_add_u32 m0, s58, 0
    s_mov_b32 s85, 0
    buffer_load_dwordx4 v4, s[12:15], s85 offen offset:0 sc1 lds
    buffer_load_dwordx4 v240, s[12:15], s85 offen offset:1024 sc1 lds
    s_mov_b32 s84, 0
    buffer_load_dwordx4 v[160:163], v4, s[92:95], s84 offen offset:0 sc1
    buffer_load_dwordx4 v[164:167], v4, s[92:95], s84 offen offset:1024 sc1
    buffer_load_dwordx4 v4, s[12:15], s85 offen offset:2048 sc1 lds
    buffer_load_dwordx4 v240, s[12:15], s85 offen offset:3072 sc1 lds
    buffer_load_dwordx4 v[168:171], v4, s[92:95], s84 offen offset:2048 sc1
    buffer_load_dwordx4 v[172:175], v4, s[92:95], s84 offen offset:3072 sc1
    s_add_u32 m0, s58, 4096
    s_mov_b32 s85, 4096
    buffer_load_dwordx4 v4, s[12:15], s85 offen offset:0 sc1 lds
    buffer_load_dwordx4 v240, s[12:15], s85 offen offset:1024 sc1 lds
    s_mov_b32 s84, 4096
    buffer_load_dwordx4 v[176:179], v4, s[92:95], s84 offen offset:0 sc1
    buffer_load_dwordx4 v[180:183], v4, s[92:95], s84 offen offset:1024 sc1
    buffer_load_dwordx4 v4, s[12:15], s85 offen offset:2048 sc1 lds
    buffer_load_dwordx4 v240, s[12:15], s85 offen offset:3072 sc1 lds
    buffer_load_dwordx4 v[184:187], v4, s[92:95], s84 offen offset:2048 sc1
    buffer_load_dwordx4 v[188:191], v4, s[92:95], s84 offen offset:3072 sc1
    s_add_u32 m0, s58, 8192
    s_mov_b32 s85, 8192
    buffer_load_dwordx4 v4, s[12:15], s85 offen offset:0 sc1 lds
    buffer_load_dwordx4 v240, s[12:15], s85 offen offset:1024 sc1 lds
    s_mov_b32 s84, 8192
    buffer_load_dwordx4 v[192:195], v4, s[92:95], s84 offen offset:0 sc1
    buffer_load_dwordx4 v[196:199], v4, s[92:95], s84 offen offset:1024 sc1
Lp2_4:
    s_waitcnt vmcnt(14) lgkmcnt(0)
    s_barrier
    ds_read_b128 a[0:3], v4 offset:0
    ds_read_b128 a[4:7], v242 offset:0
    ds_read_b128 a[8:11], v243 offset:0
    ds_read_b128 a[12:15], v10 offset:0
    ds_read_b128 a[16:19], v4 offset:1024
    ds_read_b128 a[20:23], v242 offset:1024
    ds_read_b128 a[24:27], v243 offset:1024
    ds_read_b128 a[28:31], v10 offset:1024
    s_waitcnt vmcnt(16) lgkmcnt(4)
    v_mfma_f32_16x16x32_bf16 v[48:51], a[0:3], v[160:163], 0
    ds_read_b128 a[32:35], v4 offset:2048
    v_mfma_f32_16x16x32_bf16 v[64:67], a[0:3], v[164:167], 0
    buffer_load_dword v250, v248, s[44:47], s9 offen offset:0 sc0 sc1
    v_mfma_f32_16x16x32_bf16 v[52:55], a[4:7], v[160:163], 0
    ds_read_b128 a[36:39], v242 offset:2048
    v_mfma_f32_16x16x32_bf16 v[68:71], a[4:7], v[164:167], 0
    buffer_load_dwordx4 v4, s[12:15], s85 offen offset:2048 sc1 lds
    v_mfma_f32_16x16x32_bf16 v[56:59], a[8:11], v[160:163], 0
    ds_read_b128 a[40:43], v243 offset:2048
    v_mfma_f32_16x16x32_bf16 v[72:75], a[8:11], v[164:167], 0
    buffer_load_dwordx4 v240, s[12:15], s85 offen offset:3072 sc1 lds
    v_mfma_f32_16x16x32_bf16 v[60:63], a[12:15], v[160:163], 0
    ds_read_b128 a[44:47], v10 offset:2048
    v_mfma_f32_16x16x32_bf16 v[76:79], a[12:15], v[164:167], 0
    s_waitcnt lgkmcnt(4)
    v_mfma_f32_16x16x32_bf16 v[208:211], a[16:19], v[160:163], 0
    ds_read_b128 a[0:3], v4 offset:3072
    s_add_u32 m0, s58, 12288
    v_mfma_f32_16x16x32_bf16 v[224:227], a[16:19], v[164:167], 0
    s_mov_b32 s85, 12288
    buffer_load_dwordx4 v4, s[12:15], s85 offen offset:0 sc1 lds
    v_mfma_f32_16x16x32_bf16 v[212:215], a[20:23], v[160:163], 0
    ds_read_b128 a[4:7], v242 offset:3072
    v_mfma_f32_16x16x32_bf16 v[228:231], a[20:23], v[164:167], 0
    v_mfma_f32_16x16x32_bf16 v[216:219], a[24:27], v[160:163], 0
    ds_read_b128 a[8:11], v243 offset:3072
    v_mfma_f32_16x16x32_bf16 v[232:235], a[24:27], v[164:167], 0
    buffer_load_dwordx4 v240, s[12:15], s85 offen offset:1024 sc1 lds
    v_mfma_f32_16x16x32_bf16 v[220:223], a[28:31], v[160:163], 0
    ds_read_b128 a[12:15], v10 offset:3072
    v_mfma_f32_16x16x32_bf16 v[236:239], a[28:31], v[164:167], 0
    s_waitcnt vmcnt(11) lgkmcnt(4)
    s_barrier
    v_mfma_f32_16x16x32_bf16 v[48:51], a[32:35], v[168:171], v[48:51]
    ds_read_b128 a[16:19], v4 offset:4096
    v_mfma_f32_16x16x32_bf16 v[64:67], a[32:35], v[172:175], v[64:67]
    buffer_load_dwordx4 v[200:203], v4, s[92:95], s84 offen offset:2048 sc1
    v_mfma_f32_16x16x32_bf16 v[52:55], a[36:39], v[168:171], v[52:55]
    ds_read_b128 a[20:23], v242 offset:4096
    v_mfma_f32_16x16x32_bf16 v[68:71], a[36:39], v[172:175], v[68:71]
    v_mfma_f32_16x16x32_bf16 v[56:59], a[40:43], v[168:171], v[56:59]
    ds_read_b128 a[24:27], v243 offset:4096
    v_mfma_f32_16x16x32_bf16 v[72:75], a[40:43], v[172:175], v[72:75]
    buffer_load_dwordx4 v[204:207], v4, s[92:95], s84 offen offset:3072 sc1
    v_mfma_f32_16x16x32_bf16 v[60:63], a[44:47], v[168:171], v[60:63]
    ds_read_b128 a[28:31], v10 offset:4096
    v_mfma_f32_16x16x32_bf16 v[76:79], a[44:47], v[172:175], v[76:79]
    s_waitcnt vmcnt(7) lgkmcnt(4)
    v_mfma_f32_16x16x32_bf16 v[208:211], a[0:3], v[168:171], v[208:211]
    ds_read_b128 a[32:35], v4 offset:5120
    v_mfma_f32_16x16x32_bf16 v[224:227], a[0:3], v[172:175], v[224:227]
    buffer_store_dword v14, v15, s[44:47], s80 offen offset:0 sc0 sc1
    v_mfma_f32_16x16x32_bf16 v[212:215], a[4:7], v[168:171], v[212:215]
    ds_read_b128 a[36:39], v242 offset:5120
    s_mov_b32 s84, 12288
    v_mfma_f32_16x16x32_bf16 v[228:231], a[4:7], v[172:175], v[228:231]
    buffer_load_dwordx4 v[80:83], v4, s[92:95], s84 offen offset:0 sc1
    v_mfma_f32_16x16x32_bf16 v[216:219], a[8:11], v[168:171], v[216:219]
    ds_read_b128 a[40:43], v243 offset:5120
    v_mfma_f32_16x16x32_bf16 v[232:235], a[8:11], v[172:175], v[232:235]
    buffer_load_dwordx4 v[84:87], v4, s[92:95], s84 offen offset:1024 sc1
    v_mfma_f32_16x16x32_bf16 v[220:223], a[12:15], v[168:171], v[220:223]
    ds_read_b128 a[44:47], v10 offset:5120
    v_mfma_f32_16x16x32_bf16 v[236:239], a[12:15], v[172:175], v[236:239]
    s_waitcnt vmcnt(9) lgkmcnt(4)
    v_mfma_f32_16x16x32_bf16 v[48:51], a[16:19], v[176:179], v[48:51]
    v_cmp_ne_u32 vcc, s87, v250
    ds_read_b128 a[0:3], v4 offset:6144
    v_mfma_f32_16x16x32_bf16 v[64:67], a[16:19], v[180:183], v[64:67]
    buffer_load_dwordx4 v[88:91], v4, s[92:95], s84 offen offset:2048 sc1
    v_mfma_f32_16x16x32_bf16 v[52:55], a[20:23], v[176:179], v[52:55]
    ds_read_b128 a[4:7], v242 offset:6144
    v_mfma_f32_16x16x32_bf16 v[68:71], a[20:23], v[180:183], v[68:71]
    v_mfma_f32_16x16x32_bf16 v[56:59], a[24:27], v[176:179], v[56:59]
    ds_read_b128 a[8:11], v243 offset:6144
    s_cbranch_vccnz Lrt_25
Lbk_26:
    v_mfma_f32_16x16x32_bf16 v[72:75], a[24:27], v[180:183], v[72:75]
    buffer_load_dwordx4 v4, s[12:15], s85 offen offset:2048 sc1 lds
    v_mfma_f32_16x16x32_bf16 v[60:63], a[28:31], v[176:179], v[60:63]
    ds_read_b128 a[12:15], v10 offset:6144
    v_mfma_f32_16x16x32_bf16 v[76:79], a[28:31], v[180:183], v[76:79]
    s_waitcnt vmcnt(14) lgkmcnt(4)
    s_barrier
    v_mfma_f32_16x16x32_bf16 v[208:211], a[32:35], v[176:179], v[208:211]
    ds_read_b128 a[16:19], v4 offset:7168
    v_mfma_f32_16x16x32_bf16 v[224:227], a[32:35], v[180:183], v[224:227]
    buffer_load_dwordx4 v240, s[12:15], s85 offen offset:3072 sc1 lds
    v_mfma_f32_16x16x32_bf16 v[212:215], a[36:39], v[176:179], v[212:215]
    ds_read_b128 a[20:23], v242 offset:7168
    v_mfma_f32_16x16x32_bf16 v[228:231], a[36:39], v[180:183], v[228:231]
    v_mfma_f32_16x16x32_bf16 v[216:219], a[40:43], v[176:179], v[216:219]
    ds_read_b128 a[24:27], v243 offset:7168
    s_add_u32 m0, s58, 16384
    v_mfma_f32_16x16x32_bf16 v[232:235], a[40:43], v[180:183], v[232:235]
    s_mov_b32 s85, 16384
    buffer_load_dwordx4 v4, s[12:15], s85 offen offset:0 sc1 lds
    v_mfma_f32_16x16x32_bf16 v[220:223], a[44:47], v[176:179], v[220:223]
    ds_read_b128 a[28:31], v10 offset:7168
    v_mfma_f32_16x16x32_bf16 v[236:239], a[44:47], v[180:183], v[236:239]
    s_waitcnt vmcnt(18) lgkmcnt(4)
    v_mfma_f32_16x16x32_bf16 v[48:51], a[0:3], v[184:187], v[48:51]
    ds_read_b128 a[32:35], v4 offset:8192
    v_mfma_f32_16x16x32_bf16 v[64:67], a[0:3], v[188:191], v[64:67]
    buffer_load_dwordx4 v240, s[12:15], s85 offen offset:1024 sc1 lds
    v_mfma_f32_16x16x32_bf16 v[52:55], a[4:7], v[184:187], v[52:55]
    ds_read_b128 a[36:39], v242 offset:8192
    v_mfma_f32_16x16x32_bf16 v[68:71], a[4:7], v[188:191], v[68:71]
    v_mfma_f32_16x16x32_bf16 v[56:59], a[8:11], v[184:187], v[56:59]
    ds_read_b128 a[40:43], v243 offset:8192
    v_mfma_f32_16x16x32_bf16 v[72:75], a[8:11], v[188:191], v[72:75]
    buffer_load_dwordx4 v[92:95], v4, s[92:95], s84 offen offset:3072 sc1
    v_mfma_f32_16x16x32_bf16 v[60:63], a[12:15], v[184:187], v[60:63]
    ds_read_b128 a[44:47], v10 offset:8192
    v_mfma_f32_16x16x32_bf16 v[76:79], a[12:15], v[188:191], v[76:79]
    s_waitcnt lgkmcnt(4)
    v_mfma_f32_16x16x32_bf16 v[208:211], a[16:19], v[184:187], v[208:211]
    ds_read_b128 a[0:3], v4 offset:9216
    v_mfma_f32_16x16x32_bf16 v[224:227], a[16:19], v[188:191], v[224:227]
    buffer_load_dwordx4 v4, s[12:15], s85 offen offset:2048 sc1 lds
    v_mfma_f32_16x16x32_bf16 v[212:215], a[20:23], v[184:187], v[212:215]
    ds_read_b128 a[4:7], v242 offset:9216
    v_mfma_f32_16x16x32_bf16 v[228:231], a[20:23], v[188:191], v[228:231]
    v_mfma_f32_16x16x32_bf16 v[216:219], a[24:27], v[184:187], v[216:219]
    ds_read_b128 a[8:11], v243 offset:9216
    v_mfma_f32_16x16x32_bf16 v[232:235], a[24:27], v[188:191], v[232:235]
    buffer_load_dwordx4 v240, s[12:15], s85 offen offset:3072 sc1 lds
    v_mfma_f32_16x16x32_bf16 v[220:223], a[28:31], v[184:187], v[220:223]
    ds_read_b128 a[12:15], v10 offset:9216
    v_mfma_f32_16x16x32_bf16 v[236:239], a[28:31], v[188:191], v[236:239]
    s_waitcnt vmcnt(15) lgkmcnt(4)
    s_barrier
    v_mfma_f32_16x16x32_bf16 v[48:51], a[32:35], v[192:195], v[48:51]
    ds_read_b128 a[16:19], v4 offset:10240
    s_mov_b32 s84, 16384
    v_mfma_f32_16x16x32_bf16 v[64:67], a[32:35], v[196:199], v[64:67]
    buffer_load_dwordx4 v[96:99], v4, s[92:95], s84 offen offset:0 sc1
    v_mfma_f32_16x16x32_bf16 v[52:55], a[36:39], v[192:195], v[52:55]
    ds_read_b128 a[20:23], v242 offset:10240
    v_mfma_f32_16x16x32_bf16 v[68:71], a[36:39], v[196:199], v[68:71]
    v_mfma_f32_16x16x32_bf16 v[56:59], a[40:43], v[192:195], v[56:59]
    ds_read_b128 a[24:27], v243 offset:10240
    v_mfma_f32_16x16x32_bf16 v[72:75], a[40:43], v[196:199], v[72:75]
    buffer_load_dwordx4 v[100:103], v4, s[92:95], s84 offen offset:1024 sc1
    v_mfma_f32_16x16x32_bf16 v[60:63], a[44:47], v[192:195], v[60:63]
    ds_read_b128 a[28:31], v10 offset:10240
    v_mfma_f32_16x16x32_bf16 v[76:79], a[44:47], v[196:199], v[76:79]
    s_waitcnt lgkmcnt(4)
    v_mfma_f32_16x16x32_bf16 v[208:211], a[0:3], v[192:195], v[208:211]
    ds_read_b128 a[32:35], v4 offset:11264
    s_add_u32 m0, s58, 20480
    v_mfma_f32_16x16x32_bf16 v[224:227], a[0:3], v[196:199], v[224:227]
    s_mov_b32 s85, 20480
    buffer_load_dwordx4 v4, s[12:15], s85 offen offset:0 sc1 lds
    v_mfma_f32_16x16x32_bf16 v[212:215], a[4:7], v[192:195], v[212:215]
    ds_read_b128 a[36:39], v242 offset:11264
    v_mfma_f32_16x16x32_bf16 v[228:231], a[4:7], v[196:199], v[228:231]
    v_mfma_f32_16x16x32_bf16 v[216:219], a[8:11], v[192:195], v[216:219]
    ds_read_b128 a[40:43], v243 offset:11264
    v_mfma_f32_16x16x32_bf16 v[232:235], a[8:11], v[196:199], v[232:235]
    buffer_load_dwordx4 v240, s[12:15], s85 offen offset:1024 sc1 lds
    v_mfma_f32_16x16x32_bf16 v[220:223], a[12:15], v[192:195], v[220:223]
    ds_read_b128 a[44:47], v10 offset:11264
    v_mfma_f32_16x16x32_bf16 v[236:239], a[12:15], v[196:199], v[236:239]
    s_waitcnt vmcnt(15) lgkmcnt(4)
    s_barrier
    v_mfma_f32_16x16x32_bf16 v[48:51], a[16:19], v[200:203], v[48:51]
    ds_read_b128 a[0:3], v4 offset:12288
    v_mfma_f32_16x16x32_bf16 v[64:67], a[16:19], v[204:207], v[64:67]
    buffer_load_dwordx4 v[104:107], v4, s[92:95], s84 offen offset:2048 sc1
    v_mfma_f32_16x16x32_bf16 v[52:55], a[20:23], v[200:203], v[52:55]
    ds_read_b128 a[4:7], v242 offset:12288
    v_mfma_f32_16x16x32_bf16 v[68:71], a[20:23], v[204:207], v[68:71]
    v_mfma_f32_16x16x32_bf16 v[56:59], a[24:27], v[200:203], v[56:59]
    ds_read_b128 a[8:11], v243 offset:12288
    v_mfma_f32_16x16x32_bf16 v[72:75], a[24:27], v[204:207], v[72:75]
    buffer_load_dwordx4 v[108:111], v4, s[92:95], s84 offen offset:3072 sc1
    v_mfma_f32_16x16x32_bf16 v[60:63], a[28:31], v[200:203], v[60:63]
    ds_read_b128 a[12:15], v10 offset:12288
    v_mfma_f32_16x16x32_bf16 v[76:79], a[28:31], v[204:207], v[76:79]
    s_waitcnt lgkmcnt(4)
    v_mfma_f32_16x16x32_bf16 v[208:211], a[32:35], v[200:203], v[208:211]
    ds_read_b128 a[16:19], v4 offset:13312
    v_mfma_f32_16x16x32_bf16 v[224:227], a[32:35], v[204:207], v[224:227]
    buffer_load_dwordx4 v4, s[12:15], s85 offen offset:2048 sc1 lds
    v_mfma_f32_16x16x32_bf16 v[212:215], a[36:39], v[200:203], v[212:215]
    ds_read_b128 a[20:23], v242 offset:13312
    v_mfma_f32_16x16x32_bf16 v[228:231], a[36:39], v[204:207], v[228:231]
    v_mfma_f32_16x16x32_bf16 v[216:219], a[40:43], v[200:203], v[216:219]
    ds_read_b128 a[24:27], v243 offset:13312
    v_mfma_f32_16x16x32_bf16 v[232:235], a[40:43], v[204:207], v[232:235]
    buffer_load_dwordx4 v240, s[12:15], s85 offen offset:3072 sc1 lds
    v_mfma_f32_16x16x32_bf16 v[220:223], a[44:47], v[200:203], v[220:223]
    ds_read_b128 a[28:31], v10 offset:13312
    v_mfma_f32_16x16x32_bf16 v[236:239], a[44:47], v[204:207], v[236:239]
    s_waitcnt vmcnt(13) lgkmcnt(4)
    s_barrier
    v_mfma_f32_16x16x32_bf16 v[48:51], a[0:3], v[80:83], v[48:51]
    ds_read_b128 a[32:35], v4 offset:14336
    s_add_u32 m0, s58, 24576
    v_mfma_f32_16x16x32_bf16 v[64:67], a[0:3], v[84:87], v[64:67]
    s_mov_b32 s85, 24576
    buffer_load_dwordx4 v4, s[12:15], s85 offen offset:0 sc1 lds
    v_mfma_f32_16x16x32_bf16 v[52:55], a[4:7], v[80:83], v[52:55]
    ds_read_b128 a[36:39], v242 offset:14336
    v_mfma_f32_16x16x32_bf16 v[68:71], a[4:7], v[84:87], v[68:71]
    v_mfma_f32_16x16x32_bf16 v[56:59], a[8:11], v[80:83], v[56:59]
    ds_read_b128 a[40:43], v243 offset:14336
    s_mov_b32 s84, 20480
    v_mfma_f32_16x16x32_bf16 v[72:75], a[8:11], v[84:87], v[72:75]
    buffer_load_dwordx4 v[112:115], v4, s[92:95], s84 offen offset:0 sc1
    v_mfma_f32_16x16x32_bf16 v[60:63], a[12:15], v[80:83], v[60:63]
    ds_read_b128 a[44:47], v10 offset:14336
    v_mfma_f32_16x16x32_bf16 v[76:79], a[12:15], v[84:87], v[76:79]
    s_waitcnt lgkmcnt(4)
    v_mfma_f32_16x16x32_bf16 v[208:211], a[16:19], v[80:83], v[208:211]
    ds_read_b128 a[0:3], v4 offset:15360
    v_mfma_f32_16x16x32_bf16 v[224:227], a[16:19], v[84:87], v[224:227]
    buffer_load_dwordx4 v[116:119], v4, s[92:95], s84 offen offset:1024 sc1
    v_mfma_f32_16x16x32_bf16 v[212:215], a[20:23], v[80:83], v[212:215]
    ds_read_b128 a[4:7], v242 offset:15360
    v_mfma_f32_16x16x32_bf16 v[228:231], a[20:23], v[84:87], v[228:231]
    v_mfma_f32_16x16x32_bf16 v[216:219], a[24:27], v[80:83], v[216:219]
    ds_read_b128 a[8:11], v243 offset:15360
    v_mfma_f32_16x16x32_bf16 v[232:235], a[24:27], v[84:87], v[232:235]
    buffer_load_dwordx4 v[120:123], v4, s[92:95], s84 offen offset:2048 sc1
    v_mfma_f32_16x16x32_bf16 v[220:223], a[28:31], v[80:83], v[220:223]
    ds_read_b128 a[12:15], v10 offset:15360
    v_mfma_f32_16x16x32_bf16 v[236:239], a[28:31], v[84:87], v[236:239]
    s_waitcnt vmcnt(14) lgkmcnt(4)
    s_barrier
    v_mfma_f32_16x16x32_bf16 v[48:51], a[32:35], v[88:91], v[48:51]
    ds_read_b128 a[16:19], v4 offset:16384
    v_mfma_f32_16x16x32_bf16 v[64:67], a[32:35], v[92:95], v[64:67]
    buffer_load_dwordx4 v[124:127], v4, s[92:95], s84 offen offset:3072 sc1
    v_mfma_f32_16x16x32_bf16 v[52:55], a[36:39], v[88:91], v[52:55]
    ds_read_b128 a[20:23], v242 offset:16384
    v_mfma_f32_16x16x32_bf16 v[68:71], a[36:39], v[92:95], v[68:71]
    v_mfma_f32_16x16x32_bf16 v[56:59], a[40:43], v[88:91], v[56:59]
    ds_read_b128 a[24:27], v243 offset:16384
    v_mfma_f32_16x16x32_bf16 v[72:75], a[40:43], v[92:95], v[72:75]
    buffer_load_dwordx4 v240, s[12:15], s85 offen offset:1024 sc1 lds
    v_mfma_f32_16x16x32_bf16 v[60:63], a[44:47], v[88:91], v[60:63]
    ds_read_b128 a[28:31], v10 offset:16384
    v_mfma_f32_16x16x32_bf16 v[76:79], a[44:47], v[92:95], v[76:79]
    s_waitcnt lgkmcnt(4)
    v_mfma_f32_16x16x32_bf16 v[208:211], a[0:3], v[88:91], v[208:211]
    ds_read_b128 a[32:35], v4 offset:17408
    v_mfma_f32_16x16x32_bf16 v[224:227], a[0:3], v[92:95], v[224:227]
    buffer_load_dwordx4 v4, s[12:15], s85 offen offset:2048 sc1 lds
    v_mfma_f32_16x16x32_bf16 v[212:215], a[4:7], v[88:91], v[212:215]
    ds_read_b128 a[36:39], v242 offset:17408
    v_mfma_f32_16x16x32_bf16 v[228:231], a[4:7], v[92:95], v[228:231]
    v_mfma_f32_16x16x32_bf16 v[216:219], a[8:11], v[88:91], v[216:219]
    ds_read_b128 a[40:43], v243 offset:17408
    v_mfma_f32_16x16x32_bf16 v[232:235], a[8:11], v[92:95], v[232:235]
    buffer_load_dwordx4 v240, s[12:15], s85 offen offset:3072 sc1 lds
    v_mfma_f32_16x16x32_bf16 v[220:223], a[12:15], v[88:91], v[220:223]
    ds_read_b128 a[44:47], v10 offset:17408
    v_mfma_f32_16x16x32_bf16 v[236:239], a[12:15], v[92:95], v[236:239]
    s_waitcnt vmcnt(14) lgkmcnt(4)
    s_barrier
    v_mfma_f32_16x16x32_bf16 v[48:51], a[16:19], v[96:99], v[48:51]
    ds_read_b128 a[0:3], v4 offset:18432
    v_mfma_f32_16x16x32_bf16 v[64:67], a[16:19], v[100:103], v[64:67]
    buffer_load_dword v251, v248, s[44:47], s10 offen offset:0 sc0 sc1
    v_mfma_f32_16x16x32_bf16 v[52:55], a[20:23], v[96:99], v[52:55]
    ds_read_b128 a[4:7], v242 offset:18432
    s_mov_b32 s84, 24576
    v_mfma_f32_16x16x32_bf16 v[68:71], a[20:23], v[100:103], v[68:71]
    buffer_load_dwordx4 v[128:131], v4, s[92:95], s84 offen offset:0 sc1
    v_mfma_f32_16x16x32_bf16 v[56:59], a[24:27], v[96:99], v[56:59]
    ds_read_b128 a[8:11], v243 offset:18432
    v_mfma_f32_16x16x32_bf16 v[72:75], a[24:27], v[100:103], v[72:75]
    buffer_load_dwordx4 v[132:135], v4, s[92:95], s84 offen offset:1024 sc1
    v_mfma_f32_16x16x32_bf16 v[60:63], a[28:31], v[96:99], v[60:63]
    ds_read_b128 a[12:15], v10 offset:18432
    v_mfma_f32_16x16x32_bf16 v[76:79], a[28:31], v[100:103], v[76:79]
    s_waitcnt lgkmcnt(4)
    v_mfma_f32_16x16x32_bf16 v[208:211], a[32:35], v[96:99], v[208:211]
    ds_read_b128 a[16:19], v4 offset:19456
    v_mfma_f32_16x16x32_bf16 v[224:227], a[32:35], v[100:103], v[224:227]
    buffer_load_dwordx4 v[136:139], v4, s[92:95], s84 offen offset:2048 sc1
    v_mfma_f32_16x16x32_bf16 v[212:215], a[36:39], v[96:99], v[212:215]
    ds_read_b128 a[20:23], v242 offset:19456
    v_mfma_f32_16x16x32_bf16 v[228:231], a[36:39], v[100:103], v[228:231]
    v_mfma_f32_16x16x32_bf16 v[216:219], a[40:43], v[96:99], v[216:219]
    ds_read_b128 a[24:27], v243 offset:19456
    v_mfma_f32_16x16x32_bf16 v[232:235], a[40:43], v[100:103], v[232:235]
    buffer_load_dwordx4 v[140:143], v4, s[92:95], s84 offen offset:3072 sc1
    v_mfma_f32_16x16x32_bf16 v[220:223], a[44:47], v[96:99], v[220:223]
    ds_read_b128 a[28:31], v10 offset:19456
    v_mfma_f32_16x16x32_bf16 v[236:239], a[44:47], v[100:103], v[236:239]
    s_waitcnt vmcnt(15) lgkmcnt(4)
    s_barrier
    v_mfma_f32_16x16x32_bf16 v[48:51], a[0:3], v[104:107], v[48:51]
    ds_read_b128 a[32:35], v4 offset:20480
    s_mov_b32 s84, 28672
    v_mfma_f32_16x16x32_bf16 v[64:67], a[0:3], v[108:111], v[64:67]
    buffer_load_dwordx4 v[144:147], v4, s[92:95], s84 offen offset:0 sc1
    v_mfma_f32_16x16x32_bf16 v[52:55], a[4:7], v[104:107], v[52:55]
    ds_read_b128 a[36:39], v242 offset:20480
    v_mfma_f32_16x16x32_bf16 v[68:71], a[4:7], v[108:111], v[68:71]
    v_mfma_f32_16x16x32_bf16 v[56:59], a[8:11], v[104:107], v[56:59]
    ds_read_b128 a[40:43], v243 offset:20480
    v_mfma_f32_16x16x32_bf16 v[72:75], a[8:11], v[108:111], v[72:75]
    buffer_load_dwordx4 v[148:151], v4, s[92:95], s84 offen offset:1024 sc1
    v_mfma_f32_16x16x32_bf16 v[60:63], a[12:15], v[104:107], v[60:63]
    ds_read_b128 a[44:47], v10 offset:20480
    v_mfma_f32_16x16x32_bf16 v[76:79], a[12:15], v[108:111], v[76:79]
    s_waitcnt lgkmcnt(4)
    v_mfma_f32_16x16x32_bf16 v[208:211], a[16:19], v[104:107], v[208:211]
    ds_read_b128 a[0:3], v4 offset:21504
    v_mfma_f32_16x16x32_bf16 v[224:227], a[16:19], v[108:111], v[224:227]
    buffer_load_dwordx4 v[152:155], v4, s[92:95], s84 offen offset:2048 sc1
    v_mfma_f32_16x16x32_bf16 v[212:215], a[20:23], v[104:107], v[212:215]
    ds_read_b128 a[4:7], v242 offset:21504
    v_mfma_f32_16x16x32_bf16 v[228:231], a[20:23], v[108:111], v[228:231]
    v_mfma_f32_16x16x32_bf16 v[216:219], a[24:27], v[104:107], v[216:219]
    ds_read_b128 a[8:11], v243 offset:21504
    v_mfma_f32_16x16x32_bf16 v[232:235], a[24:27], v[108:111], v[232:235]
    buffer_load_dwordx4 v[156:159], v4, s[92:95], s84 offen offset:3072 sc1
    v_mfma_f32_16x16x32_bf16 v[220:223], a[28:31], v[104:107], v[220:223]
    ds_read_b128 a[12:15], v10 offset:21504
    v_mfma_f32_16x16x32_bf16 v[236:239], a[28:31], v[108:111], v[236:239]
    s_waitcnt vmcnt(8) lgkmcnt(4)
    s_barrier
    v_mfma_f32_16x16x32_bf16 v[48:51], a[32:35], v[112:115], v[48:51]
    v_cmp_ne_u32 vcc, s87, v251
    ds_read_b128 a[16:19], v4 offset:22528
    s_mov_b32 s84, 32768
    v_mfma_f32_16x16x32_bf16 v[64:67], a[32:35], v[116:119], v[64:67]
    buffer_load_dwordx4 v[160:163], v4, s[92:95], s84 offen offset:0 sc1
    v_mfma_f32_16x16x32_bf16 v[52:55], a[36:39], v[112:115], v[52:55]
    ds_read_b128 a[20:23], v242 offset:22528
    v_mfma_f32_16x16x32_bf16 v[68:71], a[36:39], v[116:119], v[68:71]
    v_mfma_f32_16x16x32_bf16 v[56:59], a[40:43], v[112:115], v[56:59]
    ds_read_b128 a[24:27], v243 offset:22528
    s_cbranch_vccnz Lrt_27
Lbk_28:
    s_add_u32 m0, s58, 28672
    v_mfma_f32_16x16x32_bf16 v[72:75], a[40:43], v[116:119], v[72:75]
    s_mov_b32 s85, 28672
    buffer_load_dwordx4 v4, s[12:15], s85 offen offset:0 sc1 lds
    v_mfma_f32_16x16x32_bf16 v[60:63], a[44:47], v[112:115], v[60:63]
    ds_read_b128 a[28:31], v10 offset:22528
    v_mfma_f32_16x16x32_bf16 v[76:79], a[44:47], v[116:119], v[76:79]
    s_waitcnt lgkmcnt(4)
    v_mfma_f32_16x16x32_bf16 v[208:211], a[0:3], v[112:115], v[208:211]
    ds_read_b128 a[32:35], v4 offset:23552
    v_mfma_f32_16x16x32_bf16 v[224:227], a[0:3], v[116:119], v[224:227]
    buffer_load_dwordx4 v4, s[12:15], s85 offen offset:2048 sc1 lds
    v_mfma_f32_16x16x32_bf16 v[212:215], a[4:7], v[112:115], v[212:215]
    ds_read_b128 a[36:39], v242 offset:23552
    v_mfma_f32_16x16x32_bf16 v[228:231], a[4:7], v[116:119], v[228:231]
    v_mfma_f32_16x16x32_bf16 v[216:219], a[8:11], v[112:115], v[216:219]
    ds_read_b128 a[40:43], v243 offset:23552
    s_add_u32 m0, s58, 32768
    v_mfma_f32_16x16x32_bf16 v[232:235], a[8:11], v[116:119], v[232:235]
    s_mov_b32 s85, 32768
    buffer_load_dwordx4 v4, s[12:15], s85 offen offset:0 sc1 lds
    v_mfma_f32_16x16x32_bf16 v[220:223], a[12:15], v[112:115], v[220:223]
    ds_read_b128 a[44:47], v10 offset:23552
    v_mfma_f32_16x16x32_bf16 v[236:239], a[12:15], v[116:119], v[236:239]
    s_waitcnt vmcnt(16) lgkmcnt(4)
    v_mfma_f32_16x16x32_bf16 v[48:51], a[16:19], v[120:123], v[48:51]
    ds_read_b128 a[0:3], v4 offset:24576
    v_mfma_f32_16x16x32_bf16 v[64:67], a[16:19], v[124:127], v[64:67]
    buffer_load_dwordx4 v4, s[12:15], s85 offen offset:2048 sc1 lds
    v_mfma_f32_16x16x32_bf16 v[52:55], a[20:23], v[120:123], v[52:55]
    ds_read_b128 a[4:7], v242 offset:24576
    v_mfma_f32_16x16x32_bf16 v[68:71], a[20:23], v[124:127], v[68:71]
    v_mfma_f32_16x16x32_bf16 v[56:59], a[24:27], v[120:123], v[56:59]
    ds_read_b128 a[8:11], v243 offset:24576
    s_add_u32 m0, s58, 36864
    v_mfma_f32_16x16x32_bf16 v[72:75], a[24:27], v[124:127], v[72:75]
    s_mov_b32 s85, 36864
    buffer_load_dwordx4 v4, s[12:15], s85 offen offset:0 sc1 lds
    v_mfma_f32_16x16x32_bf16 v[60:63], a[28:31], v[120:123], v[60:63]
    ds_read_b128 a[12:15], v10 offset:24576
    v_mfma_f32_16x16x32_bf16 v[76:79], a[28:31], v[124:127], v[76:79]
    s_waitcnt vmcnt(15) lgkmcnt(4)
    s_barrier
    v_mfma_f32_16x16x32_bf16 v[208:211], a[32:35], v[120:123], v[208:211]
    ds_read_b128 a[16:19], v4 offset:25600
    v_mfma_f32_16x16x32_bf16 v[224:227], a[32:35], v[124:127], v[224:227]
    buffer_load_dwordx4 v4, s[12:15], s85 offen offset:2048 sc1 lds
    v_mfma_f32_16x16x32_bf16 v[212:215], a[36:39], v[120:123], v[212:215]
    ds_read_b128 a[20:23], v242 offset:25600
    v_mfma_f32_16x16x32_bf16 v[228:231], a[36:39], v[124:127], v[228:231]
    v_mfma_f32_16x16x32_bf16 v[216:219], a[40:43], v[120:123], v[216:219]
    ds_read_b128 a[24:27], v243 offset:25600
    v_mfma_f32_16x16x32_bf16 v[232:235], a[40:43], v[124:127], v[232:235]
    buffer_load_dwordx4 v[164:167], v4, s[92:95], s84 offen offset:1024 sc1
    v_mfma_f32_16x16x32_bf16 v[220:223], a[44:47], v[120:123], v[220:223]
    ds_read_b128 a[28:31], v10 offset:25600
    v_mfma_f32_16x16x32_bf16 v[236:239], a[44:47], v[124:127], v[236:239]
    s_waitcnt vmcnt(14) lgkmcnt(4)
    v_mfma_f32_16x16x32_bf16 v[48:51], a[0:3], v[128:131], v[48:51]
    ds_read_b128 a[32:35], v4 offset:26624
    v_mfma_f32_16x16x32_bf16 v[64:67], a[0:3], v[132:135], v[64:67]
    buffer_load_dwordx4 v[168:171], v4, s[92:95], s84 offen offset:2048 sc1
    v_mfma_f32_16x16x32_bf16 v[52:55], a[4:7], v[128:131], v[52:55]
    ds_read_b128 a[36:39], v242 offset:26624
    v_mfma_f32_16x16x32_bf16 v[68:71], a[4:7], v[132:135], v[68:71]
    v_mfma_f32_16x16x32_bf16 v[56:59], a[8:11], v[128:131], v[56:59]
    ds_read_b128 a[40:43], v243 offset:26624
    v_mfma_f32_16x16x32_bf16 v[72:75], a[8:11], v[132:135], v[72:75]
    buffer_load_dwordx4 v[172:175], v4, s[92:95], s84 offen offset:3072 sc1
    v_mfma_f32_16x16x32_bf16 v[60:63], a[12:15], v[128:131], v[60:63]
    ds_read_b128 a[44:47], v10 offset:26624
    v_mfma_f32_16x16x32_bf16 v[76:79], a[12:15], v[132:135], v[76:79]
    s_waitcnt lgkmcnt(4)
    v_mfma_f32_16x16x32_bf16 v[208:211], a[16:19], v[128:131], v[208:211]
    ds_read_b128 a[0:3], v4 offset:27648
    s_add_u32 m0, s58, 28672
    v_mfma_f32_16x16x32_bf16 v[224:227], a[16:19], v[132:135], v[224:227]
    s_mov_b32 s85, 28672
    buffer_load_dwordx4 v240, s[12:15], s85 offen offset:1024 sc1 lds
    v_mfma_f32_16x16x32_bf16 v[212:215], a[20:23], v[128:131], v[212:215]
    ds_read_b128 a[4:7], v242 offset:27648
    v_mfma_f32_16x16x32_bf16 v[228:231], a[20:23], v[132:135], v[228:231]
    v_mfma_f32_16x16x32_bf16 v[216:219], a[24:27], v[128:131], v[216:219]
    ds_read_b128 a[8:11], v243 offset:27648
    v_mfma_f32_16x16x32_bf16 v[232:235], a[24:27], v[132:135], v[232:235]
    buffer_load_dwordx4 v240, s[12:15], s85 offen offset:3072 sc1 lds
    v_mfma_f32_16x16x32_bf16 v[220:223], a[28:31], v[128:131], v[220:223]
    ds_read_b128 a[12:15], v10 offset:27648
    v_mfma_f32_16x16x32_bf16 v[236:239], a[28:31], v[132:135], v[236:239]
    s_waitcnt vmcnt(9) lgkmcnt(4)
    s_barrier
    v_mfma_f32_16x16x32_bf16 v[48:51], a[32:35], v[136:139], v[48:51]
    ds_read_b128 a[16:19], v4 offset:28672
    s_mov_b32 s84, 36864
    v_mfma_f32_16x16x32_bf16 v[64:67], a[32:35], v[140:143], v[64:67]
    buffer_load_dwordx4 v[176:179], v4, s[92:95], s84 offen offset:0 sc1
    v_mfma_f32_16x16x32_bf16 v[52:55], a[36:39], v[136:139], v[52:55]
    ds_read_b128 a[20:23], v242 offset:28672
    v_mfma_f32_16x16x32_bf16 v[68:71], a[36:39], v[140:143], v[68:71]
    v_mfma_f32_16x16x32_bf16 v[56:59], a[40:43], v[136:139], v[56:59]
    ds_read_b128 a[24:27], v243 offset:28672
    v_mfma_f32_16x16x32_bf16 v[72:75], a[40:43], v[140:143], v[72:75]
    buffer_load_dwordx4 v[180:183], v4, s[92:95], s84 offen offset:1024 sc1
    v_mfma_f32_16x16x32_bf16 v[60:63], a[44:47], v[136:139], v[60:63]
    ds_read_b128 a[28:31], v10 offset:28672
    v_mfma_f32_16x16x32_bf16 v[76:79], a[44:47], v[140:143], v[76:79]
    s_waitcnt lgkmcnt(4)
    v_mfma_f32_16x16x32_bf16 v[208:211], a[0:3], v[136:139], v[208:211]
    ds_read_b128 a[32:35], v4 offset:30720
    v_mfma_f32_16x16x32_bf16 v[224:227], a[0:3], v[140:143], v[224:227]
    buffer_load_dwordx4 v[184:187], v4, s[92:95], s84 offen offset:2048 sc1
    v_mfma_f32_16x16x32_bf16 v[212:215], a[4:7], v[136:139], v[212:215]
    ds_read_b128 a[36:39], v242 offset:30720
    v_mfma_f32_16x16x32_bf16 v[228:231], a[4:7], v[140:143], v[228:231]
    v_mfma_f32_16x16x32_bf16 v[216:219], a[8:11], v[136:139], v[216:219]
    ds_read_b128 a[40:43], v243 offset:30720
    v_mfma_f32_16x16x32_bf16 v[232:235], a[8:11], v[140:143], v[232:235]
    buffer_load_dwordx4 v[188:191], v4, s[92:95], s84 offen offset:3072 sc1
    v_mfma_f32_16x16x32_bf16 v[220:223], a[12:15], v[136:139], v[220:223]
    ds_read_b128 a[44:47], v10 offset:30720
    v_mfma_f32_16x16x32_bf16 v[236:239], a[12:15], v[140:143], v[236:239]
    s_waitcnt vmcnt(11) lgkmcnt(4)
    s_barrier
    v_mfma_f32_16x16x32_bf16 v[48:51], a[16:19], v[144:147], v[48:51]
    ds_read_b128 a[0:3], v4 offset:32768
    s_add_u32 m0, s58, 32768
    v_mfma_f32_16x16x32_bf16 v[64:67], a[16:19], v[148:151], v[64:67]
    s_mov_b32 s85, 32768
    buffer_load_dwordx4 v240, s[12:15], s85 offen offset:1024 sc1 lds
    v_mfma_f32_16x16x32_bf16 v[52:55], a[20:23], v[144:147], v[52:55]
    ds_read_b128 a[4:7], v242 offset:32768
    v_mfma_f32_16x16x32_bf16 v[68:71], a[20:23], v[148:151], v[68:71]
    v_mfma_f32_16x16x32_bf16 v[56:59], a[24:27], v[144:147], v[56:59]
    ds_read_b128 a[8:11], v243 offset:32768
    v_mfma_f32_16x16x32_bf16 v[72:75], a[24:27], v[148:151], v[72:75]
    buffer_load_dwordx4 v240, s[12:15], s85 offen offset:3072 sc1 lds
    v_mfma_f32_16x16x32_bf16 v[60:63], a[28:31], v[144:147], v[60:63]
    ds_read_b128 a[12:15], v10 offset:32768
    v_mfma_f32_16x16x32_bf16 v[76:79], a[28:31], v[148:151], v[76:79]
    s_waitcnt vmcnt(18) lgkmcnt(4)
    v_mfma_f32_16x16x32_bf16 v[48:51], a[32:35], v[152:155], v[48:51]
    ds_read_b128 a[16:19], v4 offset:34816
    s_add_u32 m0, s58, 36864
    v_mfma_f32_16x16x32_bf16 v[64:67], a[32:35], v[156:159], v[64:67]
    s_mov_b32 s85, 36864
    buffer_load_dwordx4 v240, s[12:15], s85 offen offset:1024 sc1 lds
    v_mfma_f32_16x16x32_bf16 v[52:55], a[36:39], v[152:155], v[52:55]
    ds_read_b128 a[20:23], v242 offset:34816
    v_mfma_f32_16x16x32_bf16 v[68:71], a[36:39], v[156:159], v[68:71]
    v_mfma_f32_16x16x32_bf16 v[56:59], a[40:43], v[152:155], v[56:59]
    ds_read_b128 a[24:27], v243 offset:34816
    v_mfma_f32_16x16x32_bf16 v[72:75], a[40:43], v[156:159], v[72:75]
    buffer_load_dwordx4 v240, s[12:15], s85 offen offset:3072 sc1 lds
    v_mfma_f32_16x16x32_bf16 v[60:63], a[44:47], v[152:155], v[60:63]
    ds_read_b128 a[28:31], v10 offset:34816
    v_mfma_f32_16x16x32_bf16 v[76:79], a[44:47], v[156:159], v[76:79]
    s_waitcnt vmcnt(12) lgkmcnt(4)
    s_barrier
    v_mfma_f32_16x16x32_bf16 v[48:51], a[0:3], v[160:163], v[48:51]
    ds_read_b128 a[32:35], v4 offset:36864
    v_mfma_f32_16x16x32_bf16 v[64:67], a[0:3], v[164:167], v[64:67]
    v_mfma_f32_16x16x32_bf16 v[52:55], a[4:7], v[160:163], v[52:55]
    ds_read_b128 a[36:39], v242 offset:36864
    v_mfma_f32_16x16x32_bf16 v[68:71], a[4:7], v[164:167], v[68:71]
    v_mfma_f32_16x16x32_bf16 v[56:59], a[8:11], v[160:163], v[56:59]
    ds_read_b128 a[40:43], v243 offset:36864
    v_mfma_f32_16x16x32_bf16 v[72:75], a[8:11], v[164:167], v[72:75]
    v_mfma_f32_16x16x32_bf16 v[60:63], a[12:15], v[160:163], v[60:63]
    ds_read_b128 a[44:47], v10 offset:36864
    v_mfma_f32_16x16x32_bf16 v[76:79], a[12:15], v[164:167], v[76:79]
    s_waitcnt vmcnt(10) lgkmcnt(4)
    v_mfma_f32_16x16x32_bf16 v[48:51], a[16:19], v[168:171], v[48:51]
    ds_read_b128 a[0:3], v4 offset:38912
    v_mfma_f32_16x16x32_bf16 v[64:67], a[16:19], v[172:175], v[64:67]
    v_mfma_f32_16x16x32_bf16 v[52:55], a[20:23], v[168:171], v[52:55]
    ds_read_b128 a[4:7], v242 offset:38912
    v_mfma_f32_16x16x32_bf16 v[68:71], a[20:23], v[172:175], v[68:71]
    v_mfma_f32_16x16x32_bf16 v[56:59], a[24:27], v[168:171], v[56:59]
    ds_read_b128 a[8:11], v243 offset:38912
    v_mfma_f32_16x16x32_bf16 v[72:75], a[24:27], v[172:175], v[72:75]
    v_mfma_f32_16x16x32_bf16 v[60:63], a[28:31], v[168:171], v[60:63]
    ds_read_b128 a[12:15], v10 offset:38912
    v_mfma_f32_16x16x32_bf16 v[76:79], a[28:31], v[172:175], v[76:79]
    s_waitcnt vmcnt(6) lgkmcnt(4)
    s_barrier
    v_mfma_f32_16x16x32_bf16 v[48:51], a[32:35], v[176:179], v[48:51]
    ds_read_b128 a[16:19], v4 offset:29696
    v_mfma_f32_16x16x32_bf16 v[64:67], a[32:35], v[180:183], v[64:67]
    v_mfma_f32_16x16x32_bf16 v[52:55], a[36:39], v[176:179], v[52:55]
    ds_read_b128 a[20:23], v242 offset:29696
    v_mfma_f32_16x16x32_bf16 v[68:71], a[36:39], v[180:183], v[68:71]
    v_mfma_f32_16x16x32_bf16 v[56:59], a[40:43], v[176:179], v[56:59]
    ds_read_b128 a[24:27], v243 offset:29696
    v_mfma_f32_16x16x32_bf16 v[72:75], a[40:43], v[180:183], v[72:75]
    v_mfma_f32_16x16x32_bf16 v[60:63], a[44:47], v[176:179], v[60:63]
    ds_read_b128 a[28:31], v10 offset:29696
    v_mfma_f32_16x16x32_bf16 v[76:79], a[44:47], v[180:183], v[76:79]
    s_waitcnt vmcnt(4) lgkmcnt(4)
    v_mfma_f32_16x16x32_bf16 v[48:51], a[0:3], v[184:187], v[48:51]
    ds_read_b128 a[32:35], v4 offset:31744
    v_mfma_f32_16x16x32_bf16 v[64:67], a[0:3], v[188:191], v[64:67]
    v_mfma_f32_16x16x32_bf16 v[52:55], a[4:7], v[184:187], v[52:55]
    ds_read_b128 a[36:39], v242 offset:31744
    v_mfma_f32_16x16x32_bf16 v[68:71], a[4:7], v[188:191], v[68:71]
    v_mfma_f32_16x16x32_bf16 v[56:59], a[8:11], v[184:187], v[56:59]
    ds_read_b128 a[40:43], v243 offset:31744
    v_mfma_f32_16x16x32_bf16 v[72:75], a[8:11], v[188:191], v[72:75]
    v_mfma_f32_16x16x32_bf16 v[60:63], a[12:15], v[184:187], v[60:63]
    ds_read_b128 a[44:47], v10 offset:31744
    v_mfma_f32_16x16x32_bf16 v[76:79], a[12:15], v[188:191], v[76:79]
    s_waitcnt vmcnt(2) lgkmcnt(4)
    s_barrier
    v_mfma_f32_16x16x32_bf16 v[208:211], a[16:19], v[144:147], v[208:211]
    ds_read_b128 a[0:3], v4 offset:33792
    v_mfma_f32_16x16x32_bf16 v[224:227], a[16:19], v[148:151], v[224:227]
    v_mfma_f32_16x16x32_bf16 v[212:215], a[20:23], v[144:147], v[212:215]
    ds_read_b128 a[4:7], v242 offset:33792
    v_mfma_f32_16x16x32_bf16 v[228:231], a[20:23], v[148:151], v[228:231]
    v_mfma_f32_16x16x32_bf16 v[216:219], a[24:27], v[144:147], v[216:219]
    ds_read_b128 a[8:11], v243 offset:33792
    v_mfma_f32_16x16x32_bf16 v[232:235], a[24:27], v[148:151], v[232:235]
    v_mfma_f32_16x16x32_bf16 v[220:223], a[28:31], v[144:147], v[220:223]
    ds_read_b128 a[12:15], v10 offset:33792
    v_mfma_f32_16x16x32_bf16 v[236:239], a[28:31], v[148:151], v[236:239]
    s_waitcnt lgkmcnt(4)
    v_mfma_f32_16x16x32_bf16 v[208:211], a[32:35], v[152:155], v[208:211]
    ds_read_b128 a[16:19], v4 offset:35840
    ds_read_b128 a[20:23], v242 offset:35840
    v_mfma_f32_16x16x32_bf16 v[224:227], a[32:35], v[156:159], v[224:227]
    ds_read_b128 a[24:27], v243 offset:35840
    ds_read_b128 a[28:31], v10 offset:35840
    v_mfma_f32_16x16x32_bf16 v[212:215], a[36:39], v[152:155], v[212:215]
    v_cvt_pk_bf16_f32 v16, v48, v49
    v_cvt_pk_bf16_f32 v17, v50, v51
    v_mfma_f32_16x16x32_bf16 v[228:231], a[36:39], v[156:159], v[228:231]
    v_cvt_pk_bf16_f32 v18, v52, v53
    v_cvt_pk_bf16_f32 v19, v54, v55
    v_mfma_f32_16x16x32_bf16 v[216:219], a[40:43], v[152:155], v[216:219]
    v_cvt_pk_bf16_f32 v20, v56, v57
    v_cvt_pk_bf16_f32 v21, v58, v59
    v_mfma_f32_16x16x32_bf16 v[232:235], a[40:43], v[156:159], v[232:235]
    v_cvt_pk_bf16_f32 v22, v60, v61
    v_cvt_pk_bf16_f32 v23, v62, v63
    v_mfma_f32_16x16x32_bf16 v[220:223], a[44:47], v[152:155], v[220:223]
    ds_write_b128 v11, v[16:19] offset:0
    v_mfma_f32_16x16x32_bf16 v[236:239], a[44:47], v[156:159], v[236:239]
    ds_write_b128 v12, v[20:23] offset:0
    s_waitcnt vmcnt(0) lgkmcnt(6)
    s_barrier
    v_mfma_f32_16x16x32_bf16 v[208:211], a[0:3], v[160:163], v[208:211]
    ds_read_b128 a[32:35], v4 offset:37888
    ds_read_b128 a[36:39], v242 offset:37888
    ds_read_b128 a[40:43], v243 offset:37888
    v_mfma_f32_16x16x32_bf16 v[224:227], a[0:3], v[164:167], v[224:227]
    ds_read_b128 a[44:47], v10 offset:37888
    v_cvt_pk_bf16_f32 v24, v64, v65
    v_cvt_pk_bf16_f32 v25, v66, v67
    v_mfma_f32_16x16x32_bf16 v[212:215], a[4:7], v[160:163], v[212:215]
    v_cvt_pk_bf16_f32 v26, v68, v69
    v_cvt_pk_bf16_f32 v27, v70, v71
    v_mfma_f32_16x16x32_bf16 v[228:231], a[4:7], v[164:167], v[228:231]
    v_cvt_pk_bf16_f32 v28, v72, v73
    v_cvt_pk_bf16_f32 v29, v74, v75
    v_mfma_f32_16x16x32_bf16 v[216:219], a[8:11], v[160:163], v[216:219]
    v_cvt_pk_bf16_f32 v30, v76, v77
    v_cvt_pk_bf16_f32 v31, v78, v79
    v_mfma_f32_16x16x32_bf16 v[232:235], a[8:11], v[164:167], v[232:235]
    ds_write_b128 v11, v[24:27] offset:2048
    ds_write_b128 v12, v[28:31] offset:2048
    v_mfma_f32_16x16x32_bf16 v[220:223], a[12:15], v[160:163], v[220:223]
    ds_read_b128 v[32:35], v13 offset:0
    ds_read_b128 v[36:39], v13 offset:1024
    v_mfma_f32_16x16x32_bf16 v[236:239], a[12:15], v[164:167], v[236:239]
    ds_read_b128 v[40:43], v13 offset:2048
    ds_read_b128 v[44:47], v13 offset:3072
    s_waitcnt lgkmcnt(0)
    v_mfma_f32_16x16x32_bf16 v[208:211], a[16:19], v[168:171], v[208:211]
    ds_read_b128 a[0:3], v4 offset:39936
    v_mfma_f32_16x16x32_bf16 v[224:227], a[16:19], v[172:175], v[224:227]
    buffer_store_dwordx4 v[32:35], v5, s[32:35], s60 offen sc1
    v_mfma_f32_16x16x32_bf16 v[212:215], a[20:23], v[168:171], v[212:215]
    ds_read_b128 a[4:7], v242 offset:39936
    v_mfma_f32_16x16x32_bf16 v[228:231], a[20:23], v[172:175], v[228:231]
    buffer_store_dwordx4 v[36:39], v5, s[32:35], s61 offen sc1
    v_mfma_f32_16x16x32_bf16 v[216:219], a[24:27], v[168:171], v[216:219]
    ds_read_b128 a[8:11], v243 offset:39936
    v_mfma_f32_16x16x32_bf16 v[232:235], a[24:27], v[172:175], v[232:235]
    buffer_store_dwordx4 v[40:43], v5, s[32:35], s62 offen sc1
    v_mfma_f32_16x16x32_bf16 v[220:223], a[28:31], v[168:171], v[220:223]
    ds_read_b128 a[12:15], v10 offset:39936
    v_mfma_f32_16x16x32_bf16 v[236:239], a[28:31], v[172:175], v[236:239]
    buffer_store_dwordx4 v[44:47], v5, s[32:35], s63 offen sc1
    s_waitcnt lgkmcnt(10)
    v_mfma_f32_16x16x32_bf16 v[208:211], a[32:35], v[176:179], v[208:211]
    v_mfma_f32_16x16x32_bf16 v[224:227], a[32:35], v[180:183], v[224:227]
    v_mfma_f32_16x16x32_bf16 v[212:215], a[36:39], v[176:179], v[212:215]
    v_mfma_f32_16x16x32_bf16 v[228:231], a[36:39], v[180:183], v[228:231]
    v_mfma_f32_16x16x32_bf16 v[216:219], a[40:43], v[176:179], v[216:219]
    v_mfma_f32_16x16x32_bf16 v[232:235], a[40:43], v[180:183], v[232:235]
    v_mfma_f32_16x16x32_bf16 v[220:223], a[44:47], v[176:179], v[220:223]
    v_mfma_f32_16x16x32_bf16 v[236:239], a[44:47], v[180:183], v[236:239]
    s_waitcnt lgkmcnt(0)
    v_mfma_f32_16x16x32_bf16 v[208:211], a[0:3], v[184:187], v[208:211]
    v_mfma_f32_16x16x32_bf16 v[224:227], a[0:3], v[188:191], v[224:227]
    v_mfma_f32_16x16x32_bf16 v[212:215], a[4:7], v[184:187], v[212:215]
    v_mfma_f32_16x16x32_bf16 v[228:231], a[4:7], v[188:191], v[228:231]
    v_mfma_f32_16x16x32_bf16 v[216:219], a[8:11], v[184:187], v[216:219]
    v_mfma_f32_16x16x32_bf16 v[232:235], a[8:11], v[188:191], v[232:235]
    v_mfma_f32_16x16x32_bf16 v[220:223], a[12:15], v[184:187], v[220:223]
    v_mfma_f32_16x16x32_bf16 v[236:239], a[12:15], v[188:191], v[236:239]
    s_nop 7
    v_cvt_pk_bf16_f32 v16, v208, v209
    v_cvt_pk_bf16_f32 v17, v210, v211
    v_cvt_pk_bf16_f32 v18, v212, v213
    v_cvt_pk_bf16_f32 v19, v214, v215
    v_cvt_pk_bf16_f32 v20, v216, v217
    v_cvt_pk_bf16_f32 v21, v218, v219
    v_cvt_pk_bf16_f32 v22, v220, v221
    v_cvt_pk_bf16_f32 v23, v222, v223
    ds_write_b128 v11, v[16:19] offset:4096
    ds_write_b128 v12, v[20:23] offset:4096
    ds_read_b128 v[48:51], v13 offset:4096
    ds_read_b128 v[52:55], v13 offset:5120
    v_cvt_pk_bf16_f32 v24, v224, v225
    v_cvt_pk_bf16_f32 v25, v226, v227
    v_cvt_pk_bf16_f32 v26, v228, v229
    v_cvt_pk_bf16_f32 v27, v230, v231
    v_cvt_pk_bf16_f32 v28, v232, v233
    v_cvt_pk_bf16_f32 v29, v234, v235
    v_cvt_pk_bf16_f32 v30, v236, v237
    v_cvt_pk_bf16_f32 v31, v238, v239
    ds_write_b128 v11, v[24:27] offset:6144
    ds_write_b128 v12, v[28:31] offset:6144
    ds_read_b128 v[56:59], v13 offset:6144
    ds_read_b128 v[60:63], v13 offset:7168
    s_waitcnt lgkmcnt(5)
    buffer_store_dwordx4 v[48:51], v5, s[32:35], s64 offen sc1
    s_waitcnt lgkmcnt(4)
    buffer_store_dwordx4 v[52:55], v5, s[32:35], s65 offen sc1
    s_waitcnt lgkmcnt(1)
    buffer_store_dwordx4 v[56:59], v5, s[32:35], s66 offen sc1
    s_waitcnt lgkmcnt(0)
    buffer_store_dwordx4 v[60:63], v5, s[32:35], s67 offen sc1
Lend_1:
Lfin_2:
    s_endpgm
Lrt_25:
    s_mov_b32 s86, 0
Lrt_25_l:
    buffer_load_dword v250, v248, s[44:47], s9 offen offset:0 sc0 sc1
    s_add_u32 s86, s86, 1
    s_cmp_gt_u32 s86, 524288
    s_cbranch_scc1 Lend_1
    s_waitcnt vmcnt(0)
    v_cmp_ne_u32 vcc, s87, v250
    s_nop 4
    s_cbranch_vccnz Lrt_25_l
    s_branch Lbk_26
Lrt_27:
    s_mov_b32 s86, 0
Lrt_27_l:
    buffer_load_dword v251, v248, s[44:47], s10 offen offset:0 sc0 sc1
    s_add_u32 s86, s86, 1
    s_cmp_gt_u32 s86, 524288
    s_cbranch_scc1 Lend_1
    s_waitcnt vmcnt(0)
    v_cmp_ne_u32 vcc, s87, v251
    s_nop 4
    s_cbranch_vccnz Lrt_27_l
    s_branch Lbk_28
Lcode_end:
.section .rodata,"a"
.p2align 6
.amdhsa_kernel standalone__weight_only_int_quip__prompt_kernel
  .amdhsa_next_free_vgpr 512
  .amdhsa_next_free_sgpr 102
  .amdhsa_accum_offset 256
  .amdhsa_group_segment_fixed_size 0
  .amdhsa_kernarg_size 72
  .amdhsa_user_sgpr_count 2
  .amdhsa_user_sgpr_kernarg_segment_ptr 1
  .amdhsa_system_sgpr_workgroup_id_x 1
.end_amdhsa_kernel
```
